```python
import torch

def _softmax(x, axis=-1):
    return torch.softmax(x, dim=axis)
def _gelu(x):
    return torch.nn.functional.gelu(x, approximate="tanh")
def _silu(x):
    return torch.nn.functional.silu(x)
def _sigmoid(x):
    return torch.sigmoid(x)
def _layernorm(x, axis=-1, eps=1e-5):
    m = x.mean(dim=axis, keepdim=True)
    v = x.var(dim=axis, keepdim=True, unbiased=False)
    return (x - m) / torch.sqrt(v + eps)
def _scatter_add(tgt, idx, src, axis=0):
    return tgt.clone().index_add_(axis, idx, src)
def _segment_sum(src, seg, n):
    out = torch.zeros((n,) + src.shape[1:], dtype=src.dtype)
    return out.index_add_(0, seg, src)
def _pad(x, pw):
    flat = tuple(v for pair in reversed(pw) for v in pair)
    return torch.nn.functional.pad(x, flat)

kernel_name = 'interleave_layers__gqa_block_cached__glu_gated_bilinear__decode'

def setup_inputs():

    _w = (lambda a: (lambda t: t.to(torch.bfloat16) if t.is_floating_point() else t)(torch.as_tensor(a)))
    def _A_setup():
        B, Sq, D = 4, 1, 512
        Hq, Hkv, Sk, Dh = 32, 8, 8192, 128
        assert Hq % Hkv == 0, (Hq, Hkv)
        return {
            "x": _w((lambda *s: torch.randn(*s, dtype=torch.bfloat16) * 0.05)(B, Sq, D)),
            "k_cache": _w((lambda *s: torch.randn(*s, dtype=torch.bfloat16) * 1.6)(B, Hkv, Sk, Dh)),
            "v_cache": _w((lambda *s: torch.randn(*s, dtype=torch.bfloat16) * 0.8)(B, Hkv, Sk, Dh)),
            "wq": _w((lambda *s: torch.randn(*s, dtype=torch.bfloat16) * 1.6)(D, Hq * Dh) * (D ** -0.5)),
            "wo": _w((lambda *s: torch.randn(*s, dtype=torch.bfloat16) * 0.8)(Hq * Dh, D) * ((Hq * Dh) ** -0.5)),
        }
    _A_in = _A_setup()

    def _B_setup():
        B, S, D, F = 4, 1, 512, 1792
        return {
            "x": _w((lambda *s: torch.randn(*s, dtype=torch.bfloat16) * 0.05)(B, S, D)),
            "w_gate": _w((lambda *s: torch.randn(*s, dtype=torch.bfloat16) * 0.4)(D, F) * (D ** -0.5)),
            "w_up": _w((lambda *s: torch.randn(*s, dtype=torch.bfloat16) * 0.4)(D, F) * (D ** -0.5)),
            "w_down": _w((lambda *s: torch.randn(*s, dtype=torch.bfloat16) * 0.4)(F, D) * (F ** -0.5)),
        }
    _B_in = _B_setup()

    return {
        "A_x": _A_in["x"],
        "A_k_cache": _A_in["k_cache"],
        "A_v_cache": _A_in["v_cache"],
        "A_wq": _A_in["wq"],
        "A_wo": _A_in["wo"],
        "B_x": _B_in["x"],
        "B_w_gate": _B_in["w_gate"],
        "B_w_up": _B_in["w_up"],
        "B_w_down": _B_in["w_down"],
    }

def reference(A_x, A_k_cache, A_v_cache, A_wq, A_wo, B_x, B_w_gate, B_w_up, B_w_down):
    def _A_ref(x, k_cache, v_cache, wq, wo):
        B, Sq, D = x.shape
        Hq, Dh = 32, 128
        Hkv = k_cache.shape[1]
        rep = Hq // Hkv
        q = (lambda x, *d: x.permute(*d))((x @ wq).reshape(B, Sq, Hq, Dh), 0, 2, 1, 3)
        k = (lambda x, n, axis: torch.repeat_interleave(x, n, dim=axis))(k_cache, rep, axis=1)
        v = (lambda x, n, axis: torch.repeat_interleave(x, n, dim=axis))(v_cache, rep, axis=1)
        scores = torch.einsum("bhqd,bhkd->bhqk", q, k) * (Dh ** -0.5)
        p = _softmax(scores, axis=-1)
        o = torch.einsum("bhqk,bhkd->bhqd", p, v)
        return (lambda x, *d: x.permute(*d))(o, 0, 2, 1, 3).reshape(B, Sq, Hq * Dh) @ wo

    def _B_ref(x, w_gate, w_up, w_down):
        g = torch.einsum("bsd,df->bsf", x, w_gate)
        u = torch.einsum("bsd,df->bsf", x, w_up)
        h = g * u
        return torch.einsum("bsf,fd->bsd", h, w_down)

    x = A_x
    x = x + _A_ref(_layernorm(x, axis=-1), A_k_cache, A_v_cache, A_wq, A_wo)
    x = x + _B_ref(_layernorm(x, axis=-1), B_w_gate, B_w_up, B_w_down)
    x = x + _A_ref(_layernorm(x, axis=-1), A_k_cache, A_v_cache, A_wq, A_wo)
    x = x + _B_ref(_layernorm(x, axis=-1), B_w_gate, B_w_up, B_w_down)
    return x
```

```asm
; @launch grid=(256,1,1) block=(256,1,1) lds=159488
.amdgcn_target "amdgcn-amd-amdhsa--gfx950"
.text
.globl interleave_layers__gqa_block_cached__glu_gated_bilinear__decode_kernel
.p2align 8
.type interleave_layers__gqa_block_cached__glu_gated_bilinear__decode_kernel,@function
interleave_layers__gqa_block_cached__glu_gated_bilinear__decode_kernel:
    s_cmp_ge_u32 s2, 256
    s_cbranch_scc1 L_end
    s_load_dwordx16 s[36:51], s[0:1], 0
    s_load_dwordx8 s[52:59], s[0:1], 64
    s_getpc_b64 s[28:29]
L_pc1:
    s_sub_u32 s28, s28, L_pc1-interleave_layers__gqa_block_cached__glu_gated_bilinear__decode_kernel
    s_subb_u32 s29, s29, 0
    v_lshlrev_b32 v58, 7, v0
    v_cmp_gt_u32 vcc, 8, v0
    s_lshr_b32 s30, s2, 3
    s_and_b32 s30, s30, 31
    s_mul_i32 s30, s30, 1024
    s_and_b64 exec, exec, vcc
    s_cbranch_execz L_pc1x
    v_add_u32 v58, s30, v58
    v_min_u32 v58, L_codeend-interleave_layers__gqa_block_cached__glu_gated_bilinear__decode_kernel-4, v58
    v_mov_b32 v59, s29
    v_add_co_u32 v58, vcc, s28, v58
    s_mov_b32 m0, 158272
    s_nop 0
    v_addc_co_u32 v59, vcc, 0, v59, vcc
    global_load_lds_dword v[58:59], off
L_pc1x:
    s_mov_b64 exec, -1
    v_mov_b32 v2, 158208
    v_mov_b32 v3, 0
    ds_write2_b32 v2, v3, v3 offset0:0 offset1:1
    v_lshrrev_b32 v2, 6, v0
    v_and_b32 v3, 63, v0
    v_readfirstlane_b32 s3, v2
    v_lshlrev_b32 v1, 4, v3
    s_and_b32 s4, s2, 7
    s_lshr_b32 s5, s2, 3
    s_and_b32 s6, s5, 3
    s_lshl_b32 s28, s6, 3
    s_add_u32 s28, s28, s4
    s_lshl_b32 s24, s28, 21
    s_bitcmp1_b32 s3, 0
    s_cselect_b32 s28, 2048, 0
    s_xor_b32 s24, s24, s28
    s_bitcmp1_b32 s3, 1
    s_cselect_b32 s28, 65536, 0
    s_xor_b32 s24, s24, s28
    s_bitcmp1_b32 s5, 2
    s_cselect_b32 s28, 270336, 0
    s_xor_b32 s24, s24, s28
    s_bitcmp1_b32 s5, 3
    s_cselect_b32 s28, 131072, 0
    s_xor_b32 s24, s24, s28
    s_bitcmp1_b32 s5, 4
    s_cselect_b32 s28, 24576, 0
    s_xor_b32 s24, s24, s28
    s_bitcmp1_b32 s5, 0
    s_cselect_b32 s28, 4096, 0
    s_xor_b32 s24, s24, s28
    s_bitcmp1_b32 s5, 1
    s_cselect_b32 s28, 524288, 0
    s_xor_b32 s24, s24, s28
    s_bitcmp1_b32 s4, 0
    s_cselect_b32 s28, 4096, 0
    s_xor_b32 s24, s24, s28
    s_bitcmp1_b32 s4, 1
    s_cselect_b32 s28, 4096, 0
    s_xor_b32 s24, s24, s28
    s_bitcmp1_b32 s4, 2
    s_cselect_b32 s28, 524288, 0
    s_xor_b32 s24, s24, s28
    s_lshl_b32 s25, s3, 15
    s_mul_i32 s28, s3, 4224
    s_add_u32 s83, s28, 139264
    s_sub_u32 s29, s5, 4
    s_cmp_lt_u32 s5, 16
    s_cselect_b32 s88, s5, s29
    s_add_u32 s29, s5, 16
    s_lshr_b32 s28, s5, 2
    s_cmp_eq_u32 s28, 3
    s_cselect_b32 s88, s29, s88
    s_cselect_b32 s89, 0, 1835008
    s_cselect_b32 s98, 1, 0
    s_mul_i32 s28, s4, 28
    s_add_u32 s28, s28, s88
    s_and_b32 s28, s28, 24
    s_cmp_eq_u32 s28, 24
    s_cselect_b32 s28, 1, 0
    s_or_b32 s98, s98, s28
    s_xor_b32 s28, s5, 0
    s_lshr_b32 s28, s28, 2
    s_cmp_eq_u32 s28, 3
    s_cselect_b32 s28, 1, 0
    s_or_b32 s98, s98, s28
    v_lshrrev_b32 v2, 4, v3
    v_lshlrev_b32 v4, 4, v2
    v_xor_b32 v48, v1, v4
    v_and_b32 v48, 0xff, v48
    v_bfe_u32 v4, v1, 8, 1
    v_lshl_or_b32 v48, v4, 9, v48
    v_bfe_u32 v4, v1, 9, 1
    v_lshl_or_b32 v48, v4, 15, v48
    v_xor_b32 v49, 64, v48
    v_xor_b32 v50, 0x80, v48
    v_xor_b32 v51, 0xc0, v48
    s_mov_b32 s77, 0
    s_waitcnt lgkmcnt(0)
    s_mov_b32 s8, s38
    s_and_b32 s9, s39, 0xffff
    s_mov_b32 s10, 67108864
    s_mov_b32 s11, 0x20000
    s_add_u32 m0, s25, 0
    s_xor_b32 s97, s24, 0
    buffer_load_dwordx4 v48, s[8:11], s97 offen nt lds
    s_add_u32 m0, s25, 1024
    s_xor_b32 s97, s24, 1024
    buffer_load_dwordx4 v49, s[8:11], s97 offen nt lds
    s_add_u32 m0, s25, 2048
    s_xor_b32 s97, s24, 256
    buffer_load_dwordx4 v50, s[8:11], s97 offen nt lds
    s_add_u32 m0, s25, 3072
    s_xor_b32 s97, s24, 1280
    buffer_load_dwordx4 v51, s[8:11], s97 offen nt lds
    s_mov_b32 s12, s40
    s_and_b32 s13, s41, 0xffff
    s_mov_b32 s14, 67108864
    s_mov_b32 s15, 0x20000
    s_mov_b32 s20, s36
    s_and_b32 s21, s37, 0xffff
    s_mov_b32 s22, 4096
    s_mov_b32 s23, 0x20000
    s_mov_b32 s78, 0x000f000f
    s_mov_b32 s79, 0x000f000f
    s_mov_b32 s80, 0x00020001
    s_mov_b32 s81, 0x00080004
    v_mov_b32 v24, 0
    v_mov_b32 v25, 0
    v_mov_b32 v26, 0
    v_mov_b32 v27, 0
    v_mov_b32 v28, 0
    v_mov_b32 v29, 0
    v_mov_b32 v30, 0
    v_mov_b32 v31, 0
    v_mov_b32 v32, 0
    v_mov_b32 v33, 0
    v_mov_b32 v34, 0
    v_mov_b32 v35, 0
    v_mov_b32 v36, 0
    v_mov_b32 v37, 0
    v_mov_b32 v38, 0
    v_mov_b32 v39, 0
    v_and_b32 v72, 0xf0, v1
    v_lshlrev_b32 v72, 6, v72
    v_lshrrev_b32 v73, 8, v1
    v_lshl_add_u32 v72, v73, 4, v72
    s_lshl_b32 s28, s3, 8
    s_mov_b64 exec, s[78:79]
    buffer_load_dwordx4 v[24:27], v72, s[20:23], s28 offen offset:0
    buffer_load_dwordx4 v[28:31], v72, s[20:23], s28 offen offset:64
    buffer_load_dwordx4 v[32:35], v72, s[20:23], s28 offen offset:128
    buffer_load_dwordx4 v[36:39], v72, s[20:23], s28 offen offset:192
    s_mov_b64 exec, -1
    v_lshlrev_b32 v73, 10, v73
    v_and_b32 v74, 0xf0, v1
    v_lshrrev_b32 v74, 3, v74
    v_add_u32 v73, v73, v74
    s_lshl_b32 s28, s5, 5
    buffer_load_ushort v75, v73, s[20:23], s28 offen
    s_mov_b32 s16, s58
    s_and_b32 s17, s59, 0xffff
    s_mov_b32 s18, 4194304
    s_mov_b32 s19, 0x20000
    s_cmp_lg_u32 s3, 1
    s_cbranch_scc1 L_norst
    s_mul_i32 s28, s2, 768
    s_add_u32 s28, s28, 262144
    v_mov_b32 v68, 0xffbfffbf
    v_mov_b32 v69, 0xffbfffbf
    v_mov_b32 v70, 0xffbfffbf
    v_mov_b32 v71, 0xffbfffbf
    s_mov_b32 exec_hi, 0xffff
    buffer_store_dwordx4 v[68:71], v1, s[16:19], s28 offen sc1
    s_lshr_b32 s28, s2, 6
    s_lshl_b32 s28, s28, 14
    s_and_b32 s29, s2, 63
    s_lshl_b32 s29, s29, 7
    s_add_u32 s28, s28, s29
    s_add_u32 s96, s28, 1048576
    v_lshlrev_b32 v76, 9, v1
    s_mov_b64 exec, 3
    buffer_store_dword v68, v76, s[16:19], s96 offen sc1
    s_mov_b64 exec, -1
L_norst:
    s_add_u32 m0, s25, 4096
    s_xor_b32 s97, s24, 8192
    buffer_load_dwordx4 v48, s[8:11], s97 offen nt lds
    s_add_u32 m0, s25, 5120
    s_xor_b32 s97, s24, 9216
    s_cmp_lg_u32 s98, 0
    s_cbranch_scc1 L_big2
    s_waitcnt vmcnt(9)
L_big2:
    buffer_load_dwordx4 v49, s[8:11], s97 offen nt lds
    s_barrier
    v_lshrrev_b32 v56, 8, v1
    v_lshlrev_b32 v56, 5, v56
    v_xor_b32 v56, v1, v56
    v_and_b32 v56, 0xff, v56
    v_bfe_u32 v57, v1, 8, 1
    v_lshl_or_b32 v56, v57, 9, v56
    v_bfe_u32 v57, v1, 9, 1
    v_lshl_or_b32 v56, v57, 15, v56
    v_xor_b32 v57, 0x80, v56
    v_and_b32 v52, 0xc0, v1
    v_and_b32 v53, 0x10, v1
    v_lshl_add_u32 v52, v53, 1, v52
    v_lshrrev_b32 v53, 8, v1
    v_lshlrev_b32 v53, 4, v53
    v_xor_b32 v53, v53, v52
    v_lshl_add_u32 v52, v52, 4, v53
    v_and_b32 v53, 0x20, v1
    v_lshl_add_u32 v52, v53, 8, v52
    v_add_u32 v52, s25, v52
    v_xor_b32 v53, 64, v52
    v_xor_b32 v54, 0x80, v52
    v_xor_b32 v55, 0xc0, v52
    v_lshrrev_b32 v2, 6, v1
    v_and_b32 v3, 7, v2
    v_lshlrev_b32 v3, 5, v3
    v_lshl_add_u32 v2, v2, 8, v3
    v_and_b32 v3, 0x30, v1
    v_lshrrev_b32 v3, 1, v3
    v_add3_u32 v2, v2, v3, s25
    v_xor_b32 v3, 32, v2
    v_xor_b32 v4, 64, v2
    v_xor_b32 v5, 96, v2
    v_xor_b32 v6, 128, v2
    v_xor_b32 v7, 160, v2
    v_xor_b32 v8, 192, v2
    v_xor_b32 v9, 224, v2
    v_mov_b32 v20, 0x3f803f80
    v_mov_b32 v21, 0x3f803f80
    v_mov_b32 v22, 0x3f803f80
    v_mov_b32 v23, 0x3f803f80
    v_and_b32 v19, 0x30, v1
    v_mul_u32_u24 v16, 33, v19
    v_and_b32 v13, 0xc0, v1
    v_add3_u32 v16, v16, v13, s83
    v_add_u32 v16, 2048, v16
    v_lshrrev_b32 v17, 8, v1
    v_lshl_add_u32 v16, v17, 4, v16
    v_lshlrev_b32 v18, 11, v17
    v_lshl_add_u32 v18, v13, 2, v18
    v_lshrrev_b32 v13, 2, v19
    v_add_u32 v18, v18, v13
    s_mul_i32 s28, s3, 528
    s_add_u32 s28, s28, 141312
    v_lshrrev_b32 v17, 1, v1
    v_add_u32 v17, s28, v17
    v_and_b32 v11, 0x40, v1
    v_lshlrev_b32 v11, 1, v11
    v_lshrrev_b32 v13, 8, v1
    v_lshl_add_u32 v11, v13, 5, v11
    v_lshrrev_b32 v13, 1, v19
    v_add_u32 v11, v11, v13
    s_lshl_b32 s28, s3, 3
    s_add_u32 s28, s28, 156160
    v_lshl_add_u32 v19, v19, 1, s28
    s_lshl_b32 s28, s5, 3
    s_add_u32 s28, s28, s4
    s_lshl_b32 s28, s28, 7
    s_cmp_lt_u32 s5, 1
    s_cselect_b32 s28, s28, 4194304
    s_cmp_eq_u32 s3, 2
    s_cselect_b32 s28, s28, 4194304
    s_add_u32 s91, s28, 442368
    s_lshl_b32 s46, 1, s4
    s_xor_b32 s46, s46, 0xff
    s_mov_b32 s47, 0
    s_mov_b32 s7, 0
    s_mov_b32 s27, 4194304
    s_lshl_b32 s28, s4, 15
    s_lshl_b32 s29, s3, 13
    s_add_u32 s62, s28, s29
    s_add_u32 s63, s62, 4096
    s_lshr_b32 s28, s5, 4
    s_lshl_b32 s28, s28, 10
    s_and_b32 s30, s5, 15
    s_lshl_b32 s30, s30, 4
    s_add_u32 s28, s28, s30
    s_add_u32 s60, s62, s28
    s_lshl_b32 s29, s29, 1
    s_add_u32 s67, s29, 262144
    s_add_u32 s68, s29, 266240
    s_add_u32 s69, s29, 524288
    s_add_u32 s70, s29, 528384
    s_lshl_b32 s28, s4, 10
    s_lshl_b32 s29, s3, 8
    s_add_u32 s28, s28, s29
    s_add_u32 s64, s28, 425984
    s_lshl_b32 s28, s5, 3
    s_add_u32 s61, s64, s28
    s_and_b32 s28, s5, 7
    s_lshl_b32 s28, s28, 9
    s_lshr_b32 s29, s5, 3
    s_lshl_b32 s29, s29, 14
    s_add_u32 s65, s28, s29
    s_and_b32 s29, s5, 1
    s_lshl_b32 s31, s29, 9
    s_lshl_b32 s28, s4, 11
    s_add_u32 s72, s28, 393216
    s_lshr_b32 s28, s88, 4
    s_lshl_b32 s28, s28, 10
    s_and_b32 s29, s88, 3
    s_lshl_b32 s29, s29, 8
    s_add_u32 s28, s28, s29
    s_lshr_b32 s29, s88, 2
    s_and_b32 s29, s29, 3
    s_lshl_b32 s29, s29, 6
    s_add_u32 s28, s28, s29
    s_add_u32 s71, s72, s28
    s_lshl_b32 s28, s4, 12
    s_lshl_b32 s29, s6, 10
    s_add_u32 s74, s28, s29
    s_add_u32 s28, s28, s31
    s_and_b32 s29, s5, 6
    s_lshl_b32 s29, s29, 5
    s_add_u32 s28, s28, s29
    s_xor_b32 s29, s5, 0
    s_lshr_b32 s29, s29, 3
    s_lshl_b32 s29, s29, 4
    s_add_u32 s73, s28, s29
    s_and_b32 s28, s5, 3
    s_lshl_b32 s28, s28, 11
    s_add_u32 s76, s28, 589824
    s_lshl_b32 s28, s4, 8
    s_add_u32 s75, s76, s28
    s_getreg_b32 s82, hwreg(HW_REG_XCC_ID, 0, 3)
    s_branch L_page0
L_pad14:
L_pad15:
L_ret:
    s_setpc_b64 s[86:87]
    .p2align 12
L_page0:
    s_add_u32 m0, s25, 6144
    s_xor_b32 s97, s24, 8448
    s_cmp_lg_u32 s98, 0
    s_cbranch_scc1 L_big3
    s_waitcnt vmcnt(9)
L_big3:
    buffer_load_dwordx4 v50, s[8:11], s97 offen nt lds
    s_add_u32 m0, s25, 7168
    s_xor_b32 s97, s24, 9472
    s_cmp_lg_u32 s98, 0
    s_cbranch_scc1 L_big4
    s_waitcnt vmcnt(9)
L_big4:
    buffer_load_dwordx4 v51, s[8:11], s97 offen nt lds
    s_add_u32 m0, s25, 8192
    s_xor_b32 s97, s24, 1048576
    s_cmp_lg_u32 s98, 0
    s_cbranch_scc1 L_big5
    s_waitcnt vmcnt(9)
L_big5:
    buffer_load_dwordx4 v48, s[8:11], s97 offen nt lds
    s_mov_b32 s20, s42
    s_and_b32 s21, s43, 0xffff
    s_mov_b32 s22, 4194304
    s_mov_b32 s23, 0x20000
    v_bfe_u32 v58, v1, 5, 5
    v_and_b32 v59, 16, v1
    v_lshl_add_u32 v58, v58, 13, v59
    s_lshl_b32 s28, s3, 20
    s_lshl_b32 s29, s4, 10
    s_add_u32 s28, s28, s29
    s_xor_b32 s29, s5, 0
    s_lshl_b32 s29, s29, 5
    s_add_u32 s99, s28, s29
    s_mov_b32 s100, s83
    s_waitcnt lgkmcnt(0)
    s_lshr_b32 s28, s3, 0
    s_lshr_b32 s29, s4, 0
    s_xor_b32 s28, s28, s29
    s_and_b32 s28, s28, 3
    s_xor_b32 s28, s28, 0
    s_lshl_b32 s29, s28, 10
    s_add_u32 m0, s100, s29
    s_lshl_b32 s28, s28, 18
    s_add_u32 s30, s99, s28
    buffer_load_dwordx4 v58, s[20:23], s30 offen lds
    s_add_u32 m0, s25, 9216
    s_xor_b32 s97, s24, 1049600
    s_cmp_lg_u32 s98, 0
    s_cbranch_scc1 L_big6
    s_waitcnt vmcnt(5)
L_big6:
    buffer_load_dwordx4 v49, s[8:11], s97 offen nt lds
    s_add_u32 m0, s25, 10240
    s_xor_b32 s97, s24, 1048832
    s_cmp_lg_u32 s98, 0
    s_cbranch_scc1 L_big7
    s_waitcnt vmcnt(5)
L_big7:
    s_waitcnt vmcnt(15)
    buffer_load_dwordx4 v50, s[8:11], s97 offen nt lds
    s_add_u32 m0, s25, 11264
    s_xor_b32 s97, s24, 1049856
    s_cmp_lg_u32 s98, 0
    s_cbranch_scc1 L_big8
    s_waitcnt vmcnt(5)
L_big8:
    s_waitcnt vmcnt(15)
    buffer_load_dwordx4 v51, s[8:11], s97 offen nt lds
    s_add_u32 m0, s25, 12288
    s_xor_b32 s97, s24, 1056768
    s_cmp_lg_u32 s98, 0
    s_cbranch_scc1 L_big9
    s_waitcnt vmcnt(5)
L_big9:
    s_waitcnt vmcnt(15)
    buffer_load_dwordx4 v48, s[8:11], s97 offen nt lds
    s_add_u32 m0, s25, 13312
    s_xor_b32 s97, s24, 1057792
    s_cmp_lg_u32 s98, 0
    s_cbranch_scc1 L_big10
    s_waitcnt vmcnt(5)
L_big10:
    s_waitcnt vmcnt(15)
    buffer_load_dwordx4 v49, s[8:11], s97 offen nt lds
    s_add_u32 m0, s25, 14336
    s_xor_b32 s97, s24, 1057024
    s_cmp_lg_u32 s98, 0
    s_cbranch_scc1 L_big11
    s_waitcnt vmcnt(4)
L_big11:
    s_waitcnt vmcnt(10)
    buffer_load_dwordx4 v50, s[8:11], s97 offen nt lds
    s_lshr_b32 s28, s3, 0
    s_lshr_b32 s29, s4, 0
    s_xor_b32 s28, s28, s29
    s_and_b32 s28, s28, 3
    s_xor_b32 s28, s28, 1
    s_lshl_b32 s29, s28, 10
    s_add_u32 m0, s100, s29
    s_lshl_b32 s28, s28, 18
    s_add_u32 s30, s99, s28
    buffer_load_dwordx4 v58, s[20:23], s30 offen lds
    s_add_u32 m0, s25, 15360
    s_xor_b32 s97, s24, 1058048
    s_cmp_lg_u32 s98, 0
    s_cbranch_scc1 L_big12
    s_waitcnt vmcnt(5)
L_big12:
    s_waitcnt vmcnt(11)
    buffer_load_dwordx4 v51, s[8:11], s97 offen nt lds
    s_add_u32 m0, s25, 16384
    s_xor_b32 s97, s24, 4096
    s_cmp_lg_u32 s98, 0
    s_cbranch_scc1 L_big13
    s_waitcnt vmcnt(5)
L_big13:
    s_waitcnt vmcnt(11)
    buffer_load_dwordx4 v48, s[8:11], s97 offen nt lds
    s_add_u32 m0, s25, 17408
    s_xor_b32 s97, s24, 5120
    s_cmp_lg_u32 s98, 0
    s_cbranch_scc1 L_big14
    s_waitcnt vmcnt(5)
L_big14:
    s_waitcnt vmcnt(11)
    buffer_load_dwordx4 v49, s[8:11], s97 offen nt lds
    s_cmp_eq_u32 s3, 1
    s_cselect_b32 s28, 2, 0
    s_or_b32 s98, s98, s28
    s_cmp_lg_u32 s3, 1
    s_cbranch_scc1 L_noatom
    s_and_b32 s31, s5, 1
    s_lshl_b32 s28, s31, 13
    s_xor_b32 s28, s28, s96
    s_xor_b32 s29, s28, 8192
    s_mov_b32 s94, 0
    s_waitcnt vmcnt(16) lgkmcnt(0)
    s_load_dword s93, s[58:59], s28
    s_load_dword s94, s[58:59], s29
    s_waitcnt lgkmcnt(1)
    s_mul_i32 s28, s82, 6
    s_lshl_b64 s[28:29], 1, s28
    s_or_b32 s29, s29, 0x10000
    v_mov_b32 v60, s28
    s_lshl_b32 s28, s4, 5
    v_mov_b32 v63, s28
    v_mov_b32 v61, s29
    v_mov_b32 v62, s31
    v_lshlrev_b32 v62, 24, v62
    v_or_b32 v61, v61, v62
    s_cmp_eq_u32 s94, 0
    s_cselect_b32 s30, 0x1000000, 0
    s_waitcnt lgkmcnt(0)
    v_xor_b32 v61, s30, v61
    s_mov_b64 exec, 1
    global_atomic_add_x2 v63, v[60:61], s[56:57] sc1
    s_mov_b64 exec, -1
L_noatom:
    s_add_u32 m0, s25, 18432
    s_xor_b32 s97, s24, 4352
    s_cmp_lg_u32 s98, 0
    s_cbranch_scc1 L_big15
    s_waitcnt vmcnt(5)
L_big15:
    s_waitcnt vmcnt(11)
    buffer_load_dwordx4 v50, s[8:11], s97 offen nt lds
    s_add_u32 m0, s25, 19456
    s_xor_b32 s97, s24, 5376
    s_cmp_lg_u32 s98, 0
    s_cbranch_scc1 L_big16
    s_waitcnt vmcnt(5)
L_big16:
    s_waitcnt vmcnt(10)
    buffer_load_dwordx4 v51, s[8:11], s97 offen nt lds
    s_add_u32 m0, s25, 20480
    s_xor_b32 s97, s24, 12288
    s_cmp_lg_u32 s98, 0
    s_cbranch_scc1 L_big17
    s_waitcnt vmcnt(4)
L_big17:
    s_waitcnt vmcnt(10)
    buffer_load_dwordx4 v48, s[8:11], s97 offen nt lds
    s_lshr_b32 s28, s3, 0
    s_lshr_b32 s29, s4, 0
    s_xor_b32 s28, s28, s29
    s_and_b32 s28, s28, 3
    s_xor_b32 s28, s28, 2
    s_lshl_b32 s29, s28, 10
    s_add_u32 m0, s100, s29
    s_lshl_b32 s28, s28, 18
    s_add_u32 s30, s99, s28
    buffer_load_dwordx4 v58, s[20:23], s30 offen lds
    s_add_u32 m0, s25, 21504
    s_xor_b32 s97, s24, 13312
    s_cmp_lg_u32 s98, 0
    s_cbranch_scc1 L_big18
    s_waitcnt vmcnt(5)
L_big18:
    s_waitcnt vmcnt(11)
    buffer_load_dwordx4 v49, s[8:11], s97 offen nt lds
    ds_read_b128 a[0:3], v52 offset:0
    ds_read_b128 a[4:7], v53 offset:0
    ds_read_b128 a[8:11], v54 offset:0
    ds_read_b128 a[12:15], v55 offset:0
    v_xor_b32 v52, 0x110, v52
    v_xor_b32 v53, 0x110, v53
    v_xor_b32 v54, 0x110, v54
    v_xor_b32 v55, 0x110, v55
    ds_read_b128 a[16:19], v52 offset:0
    ds_read_b128 a[20:23], v53 offset:0
    ds_read_b128 a[24:27], v54 offset:0
    ds_read_b128 a[28:31], v55 offset:0
    s_add_u32 m0, s25, 22528
    s_xor_b32 s97, s24, 12544
    s_cmp_lg_u32 s98, 0
    s_cbranch_scc1 L_big19
    s_waitcnt vmcnt(5)
L_big19:
    s_waitcnt vmcnt(11)
    buffer_load_dwordx4 v50, s[8:11], s97 offen nt lds
    s_add_u32 m0, s25, 23552
    s_xor_b32 s97, s24, 13568
    s_cmp_lg_u32 s98, 0
    s_cbranch_scc1 L_big20
    s_waitcnt vmcnt(5)
L_big20:
    s_waitcnt vmcnt(11)
    buffer_load_dwordx4 v51, s[8:11], s97 offen nt lds
    s_add_u32 m0, s25, 24576
    s_xor_b32 s97, s24, 1052672
    s_cmp_lg_u32 s98, 0
    s_cbranch_scc1 L_big21
    s_waitcnt vmcnt(5)
L_big21:
    s_waitcnt vmcnt(11)
    buffer_load_dwordx4 v48, s[8:11], s97 offen nt lds
    s_add_u32 m0, s25, 25600
    s_xor_b32 s97, s24, 1053696
    s_cmp_lg_u32 s98, 0
    s_cbranch_scc1 L_big22
    s_waitcnt vmcnt(5)
L_big22:
    s_waitcnt vmcnt(10)
    buffer_load_dwordx4 v49, s[8:11], s97 offen nt lds
    ds_read_b128 a[48:51], v52 offset:4096
    ds_read_b128 a[52:55], v53 offset:4096
    ds_read_b128 a[56:59], v54 offset:4096
    ds_read_b128 a[60:63], v55 offset:4096
    v_xor_b32 v52, 0x110, v52
    v_xor_b32 v53, 0x110, v53
    v_xor_b32 v54, 0x110, v54
    v_xor_b32 v55, 0x110, v55
    ds_read_b128 a[32:35], v52 offset:4096
    ds_read_b128 a[36:39], v53 offset:4096
    ds_read_b128 a[40:43], v54 offset:4096
    ds_read_b128 a[44:47], v55 offset:4096
    s_mov_b64 exec, 0
    s_call_b64 s[86:87], L_pad1
    s_mov_b64 exec, -1
    s_add_u32 m0, s25, 26624
    s_xor_b32 s97, s24, 1052928
    s_cmp_lg_u32 s98, 0
    s_cbranch_scc1 L_big23
    s_waitcnt vmcnt(4)
L_big23:
    s_waitcnt vmcnt(10)
    buffer_load_dwordx4 v50, s[8:11], s97 offen nt lds
    s_lshr_b32 s28, s3, 0
    s_lshr_b32 s29, s4, 0
    s_xor_b32 s28, s28, s29
    s_and_b32 s28, s28, 3
    s_xor_b32 s28, s28, 3
    s_lshl_b32 s29, s28, 10
    s_add_u32 m0, s100, s29
    s_lshl_b32 s28, s28, 18
    s_add_u32 s30, s99, s28
    buffer_load_dwordx4 v58, s[20:23], s30 offen lds
    s_add_u32 m0, s25, 27648
    s_xor_b32 s97, s24, 1053952
    s_cmp_lg_u32 s98, 0
    s_cbranch_scc1 L_big24
    s_waitcnt vmcnt(5)
L_big24:
    s_waitcnt vmcnt(11)
    buffer_load_dwordx4 v51, s[8:11], s97 offen nt lds
    s_add_u32 m0, s25, 28672
    s_xor_b32 s97, s24, 1060864
    s_cmp_lg_u32 s98, 0
    s_cbranch_scc1 L_big25
    s_waitcnt vmcnt(5)
L_big25:
    s_waitcnt vmcnt(11)
    buffer_load_dwordx4 v48, s[8:11], s97 offen nt lds
    s_add_u32 m0, s25, 29696
    s_xor_b32 s97, s24, 1061888
    s_cmp_lg_u32 s98, 0
    s_cbranch_scc1 L_big26
    s_waitcnt vmcnt(5)
L_big26:
    s_waitcnt vmcnt(11)
    buffer_load_dwordx4 v49, s[8:11], s97 offen nt lds
    s_and_b32 s98, s98, 1
    s_mov_b64 exec, 0
    s_call_b64 s[86:87], L_pad2
    s_mov_b64 exec, -1
    s_add_u32 m0, s25, 30720
    s_xor_b32 s97, s24, 1061120
    s_cmp_lg_u32 s98, 0
    s_cbranch_scc1 L_big27
    s_waitcnt vmcnt(5)
L_big27:
    s_waitcnt vmcnt(11)
    buffer_load_dwordx4 v50, s[8:11], s97 offen nt lds
    s_add_u32 m0, s25, 31744
    s_xor_b32 s97, s24, 1062144
    s_cmp_lg_u32 s98, 0
    s_cbranch_scc1 L_big28
    s_waitcnt vmcnt(5)
L_big28:
    s_waitcnt vmcnt(10)
    buffer_load_dwordx4 v51, s[8:11], s97 offen nt lds
    s_add_u32 m0, s25, 0
    s_xor_b32 s97, s24, 524288
    s_cmp_lg_u32 s98, 0
    s_cbranch_scc1 L_big29
    s_waitcnt vmcnt(4)
L_big29:
    s_waitcnt vmcnt(10) lgkmcnt(0)
    buffer_load_dwordx4 v48, s[8:11], s97 offen nt lds
    s_mov_b32 s20, s52
    s_and_b32 s21, s53, 0xffff
    s_mov_b32 s22, 1835008
    s_mov_b32 s23, 0x20000
    v_bfe_u32 v58, v1, 5, 4
    v_and_b32 v59, 16, v1
    v_lshl_add_u32 v58, v58, 10, v59
    v_lshrrev_b32 v59, 9, v1
    v_lshl_add_u32 v58, v59, 15, v58
    s_lshl_b32 s28, s3, 16
    s_mul_i32 s29, s4, 229376
    s_add_u32 s22, s29, 229376
    s_add_u32 s28, s28, s29
    s_xor_b32 s29, s5, 0
    s_lshl_b32 s29, s29, 5
    s_add_u32 s99, s28, s29
    s_lshl_b32 s100, s3, 11
    s_add_u32 s100, s100, 131072
    s_lshr_b32 s28, s3, 0
    s_lshr_b32 s29, s4, 0
    s_xor_b32 s28, s28, s29
    s_and_b32 s28, s28, 1
    s_xor_b32 s28, s28, 0
    s_lshl_b32 s29, s28, 10
    s_add_u32 m0, s100, s29
    s_lshl_b32 s28, s28, 14
    s_add_u32 s30, s99, s28
    buffer_load_dwordx4 v58, s[20:23], s30 offen lds
    s_add_u32 m0, s25, 1024
    s_xor_b32 s97, s24, 525312
    s_cmp_lg_u32 s98, 0
    s_cbranch_scc1 L_big30
    s_waitcnt vmcnt(5)
L_big30:
    s_waitcnt vmcnt(11)
    buffer_load_dwordx4 v49, s[8:11], s97 offen nt lds
    s_mov_b64 exec, 0
    s_call_b64 s[86:87], L_pad3
    s_mov_b64 exec, -1
    s_add_u32 m0, s25, 2048
    s_xor_b32 s97, s24, 524544
    s_cmp_lg_u32 s98, 0
    s_cbranch_scc1 L_big31
    s_waitcnt vmcnt(5)
L_big31:
    s_waitcnt vmcnt(11)
    buffer_load_dwordx4 v50, s[8:11], s97 offen nt lds
    s_add_u32 m0, s25, 3072
    s_xor_b32 s97, s24, 525568
    s_cmp_lg_u32 s98, 0
    s_cbranch_scc1 L_big32
    s_waitcnt vmcnt(5)
L_big32:
    s_waitcnt vmcnt(11)
    buffer_load_dwordx4 v51, s[8:11], s97 offen nt lds
    s_add_u32 m0, s25, 4096
    s_xor_b32 s97, s24, 532480
    s_cmp_lg_u32 s98, 0
    s_cbranch_scc1 L_big33
    s_waitcnt vmcnt(5)
L_big33:
    s_waitcnt vmcnt(11)
    buffer_load_dwordx4 v48, s[8:11], s97 offen nt lds
    s_add_u32 m0, s25, 5120
    s_xor_b32 s97, s24, 533504
    s_cmp_lg_u32 s98, 0
    s_cbranch_scc1 L_big34
    s_waitcnt vmcnt(5)
L_big34:
    s_waitcnt vmcnt(10)
    buffer_load_dwordx4 v49, s[8:11], s97 offen nt lds
    ds_read_b128 a[64:67], v52 offset:16384
    ds_read_b128 a[68:71], v53 offset:16384
    ds_read_b128 a[72:75], v54 offset:16384
    ds_read_b128 a[76:79], v55 offset:16384
    v_xor_b32 v52, 0x110, v52
    v_xor_b32 v53, 0x110, v53
    v_xor_b32 v54, 0x110, v54
    v_xor_b32 v55, 0x110, v55
    ds_read_b128 a[80:83], v52 offset:16384
    ds_read_b128 a[84:87], v53 offset:16384
    ds_read_b128 a[88:91], v54 offset:16384
    ds_read_b128 a[92:95], v55 offset:16384
    s_waitcnt vmcnt(12)
    v_and_b32 v58, 0x300, v1
    v_and_b32 v59, 0xf0, v1
    v_lshrrev_b32 v59, 1, v59
    v_add_u32 v58, v58, v59
    v_add_u32 v58, s83, v58
    ds_read_b64_tr_b16 v[80:81], v58 offset:0
    ds_read_b64_tr_b16 v[82:83], v58 offset:128
    ds_read_b64_tr_b16 v[84:85], v58 offset:1024
    ds_read_b64_tr_b16 v[86:87], v58 offset:1152
    ds_read_b64_tr_b16 v[88:89], v58 offset:2048
    ds_read_b64_tr_b16 v[90:91], v58 offset:2176
    ds_read_b64_tr_b16 v[92:93], v58 offset:3072
    ds_read_b64_tr_b16 v[94:95], v58 offset:3200
    s_waitcnt vmcnt(12)
    s_waitcnt lgkmcnt(0)
    v_mfma_f32_16x16x32_bf16 v[40:43], v[24:27], v[80:83], 0
    v_mfma_f32_16x16x32_bf16 v[44:47], v[24:27], v[20:23], 0
    v_mfma_f32_16x16x32_bf16 v[64:67], v[24:27], v[24:27], 0
    v_mfma_f32_16x16x32_bf16 v[40:43], v[28:31], v[84:87], v[40:43]
    v_mfma_f32_16x16x32_bf16 v[44:47], v[28:31], v[20:23], v[44:47]
    v_mfma_f32_16x16x32_bf16 v[64:67], v[28:31], v[28:31], v[64:67]
    v_mfma_f32_16x16x32_bf16 v[40:43], v[32:35], v[88:91], v[40:43]
    v_mfma_f32_16x16x32_bf16 v[44:47], v[32:35], v[20:23], v[44:47]
    v_mfma_f32_16x16x32_bf16 v[64:67], v[32:35], v[32:35], v[64:67]
    v_mfma_f32_16x16x32_bf16 v[40:43], v[36:39], v[92:95], v[40:43]
    v_mfma_f32_16x16x32_bf16 v[44:47], v[36:39], v[20:23], v[44:47]
    v_mfma_f32_16x16x32_bf16 v[64:67], v[36:39], v[36:39], v[64:67]
    s_add_u32 m0, s25, 6144
    s_xor_b32 s97, s24, 532736
    s_cmp_lg_u32 s98, 0
    s_cbranch_scc1 L_big35
    s_waitcnt vmcnt(4)
L_big35:
    s_waitcnt vmcnt(10)
    buffer_load_dwordx4 v50, s[8:11], s97 offen nt lds
    v_lshlrev_b32 v75, 16, v75
    v_mul_f32 v75, 0x3e000000, v75
    v_lshrrev_b32 v68, 2, v1
    v_add_u32 v68, 157312, v68
    ds_write_b32 v68, v75
    v_mfma_f32_16x16x32_bf16 v[76:79], v[20:23], v[80:83], 0
    v_mfma_f32_16x16x32_bf16 v[76:79], v[20:23], v[84:87], v[76:79]
    v_mfma_f32_16x16x32_bf16 v[76:79], v[20:23], v[88:91], v[76:79]
    v_mfma_f32_16x16x32_bf16 v[76:79], v[20:23], v[92:95], v[76:79]
    s_lshl_b32 s28, s3, 2
    s_add_u32 s28, s28, 157696
    v_and_b32 v58, 0xf0, v1
    v_add_u32 v58, s28, v58
    s_nop 3
    ds_write_b32 v58, v76
    v_mov_b32 v60, v44
    v_mov_b32 v61, v45
    v_mov_b32 v62, v46
    v_mov_b32 v63, v47
    v_lshrrev_b32 v13, 8, v1
    v_permlane32_swap_b32 v60, v62
    v_permlane32_swap_b32 v61, v63
    v_pk_add_f32 v[60:61], v[60:61], v[62:63]
    v_permlane32_swap_b32 v64, v66
    v_permlane32_swap_b32 v65, v67
    v_pk_add_f32 v[64:65], v[64:65], v[66:67]
    s_lshl_b32 s28, s3, 2
    s_add_u32 s28, s28, 157568
    v_permlane16_swap_b32 v64, v65
    v_add_f32 v64, v64, v65
    v_permlane16_swap_b32 v60, v61
    v_add_f32 v60, v60, v61
    v_add_f32_dpp v64, v64, v64 row_ror:4 row_mask:0xf bank_mask:0xf
    v_lshl_add_u32 v13, v13, 4, s28
    s_nop 0
    v_add_f32_dpp v64, v64, v64 row_ror:8 row_mask:0xf bank_mask:0xf
    s_mov_b64 exec, s[80:81]
    ds_write2_b32 v13, v60, v64 offset0:0 offset1:16
    s_mov_b64 exec, -1
    s_lshl_b32 s28, s3, 8
    s_add_u32 s28, s28, 156288
    v_lshrrev_b32 v68, 2, v1
    v_add_u32 v68, s28, v68
    v_permlane32_swap_b32 v40, v42
    v_permlane32_swap_b32 v41, v43
    v_pk_add_f32 v[40:41], v[40:41], v[42:43]
    s_nop 1
    v_permlane16_swap_b32 v40, v41
    v_add_f32 v40, v40, v41
    ds_write_b32 v68, v40
    s_add_u32 m0, s25, 7168
    s_xor_b32 s97, s24, 533760
    s_cmp_lg_u32 s98, 0
    s_cbranch_scc1 L_big36
    s_waitcnt vmcnt(4)
L_big36:
    s_waitcnt vmcnt(10)
    buffer_load_dwordx4 v51, s[8:11], s97 offen nt lds
    v_mov_b32 v68, 158208
    v_mov_b32 v69, 1
    s_waitcnt lgkmcnt(0)
    s_mov_b64 exec, 1
    ds_add_u32 v68, v69
    s_mov_b64 exec, -1
    s_mov_b64 exec, 0
    s_call_b64 s[86:87], L_pad4
    s_mov_b64 exec, -1
    s_add_u32 m0, s25, 8192
    s_xor_b32 s97, s24, 1572864
    s_cmp_lg_u32 s98, 0
    s_cbranch_scc1 L_big37
    s_waitcnt vmcnt(4)
L_big37:
    s_waitcnt vmcnt(10)
    buffer_load_dwordx4 v48, s[8:11], s97 offen nt lds
    s_add_u32 m0, s25, 9216
    s_xor_b32 s97, s24, 1573888
    s_cmp_lg_u32 s98, 0
    s_cbranch_scc1 L_big38
    s_waitcnt vmcnt(4)
L_big38:
    s_waitcnt vmcnt(10)
    buffer_load_dwordx4 v49, s[8:11], s97 offen nt lds
    s_mov_b32 s20, s44
    s_and_b32 s21, s45, 0xffff
    s_mov_b32 s22, 4194304
    s_mov_b32 s23, 0x20000
    v_bfe_u32 v58, v1, 5, 3
    v_and_b32 v59, 16, v1
    v_lshl_add_u32 v58, v58, 10, v59
    v_lshrrev_b32 v59, 8, v1
    v_lshl_add_u32 v58, v59, 15, v58
    s_lshl_b32 s28, s3, 17
    s_lshl_b32 s29, s4, 19
    s_add_u32 s28, s28, s29
    s_xor_b32 s29, s5, 0
    s_lshl_b32 s29, s29, 5
    s_add_u32 s99, s28, s29
    s_mov_b32 s100, s83
    s_waitcnt lgkmcnt(0)
    s_lshr_b32 s28, s3, 0
    s_lshr_b32 s29, s4, 0
    s_xor_b32 s28, s28, s29
    s_and_b32 s28, s28, 3
    s_xor_b32 s28, s28, 0
    s_lshl_b32 s29, s28, 10
    s_add_u32 m0, s100, s29
    s_lshl_b32 s28, s28, 13
    s_add_u32 s30, s99, s28
    buffer_load_dwordx4 v58, s[20:23], s30 offen lds
    ds_read_b128 a[112:115], v52 offset:20480
    ds_read_b128 a[116:119], v53 offset:20480
    ds_read_b128 a[120:123], v54 offset:20480
    ds_read_b128 a[124:127], v55 offset:20480
    v_xor_b32 v52, 0x110, v52
    v_xor_b32 v53, 0x110, v53
    v_xor_b32 v54, 0x110, v54
    v_xor_b32 v55, 0x110, v55
    ds_read_b128 a[96:99], v52 offset:20480
    ds_read_b128 a[100:103], v53 offset:20480
    ds_read_b128 a[104:107], v54 offset:20480
    ds_read_b128 a[108:111], v55 offset:20480
    s_mov_b64 exec, 0
    s_call_b64 s[86:87], L_pad5
    s_mov_b64 exec, -1
    s_add_u32 m0, s25, 10240
    s_xor_b32 s97, s24, 1573120
    s_cmp_lg_u32 s98, 0
    s_cbranch_scc1 L_big39
    s_waitcnt vmcnt(5)
L_big39:
    s_waitcnt vmcnt(11)
    buffer_load_dwordx4 v50, s[8:11], s97 offen nt lds
    s_add_u32 m0, s25, 11264
    s_xor_b32 s97, s24, 1574144
    s_cmp_lg_u32 s98, 0
    s_cbranch_scc1 L_big40
    s_waitcnt vmcnt(5)
L_big40:
    s_waitcnt vmcnt(10)
    buffer_load_dwordx4 v51, s[8:11], s97 offen nt lds
    s_add_u32 m0, s25, 12288
    s_xor_b32 s97, s24, 1581056
    s_cmp_lg_u32 s98, 0
    s_cbranch_scc1 L_big41
    s_waitcnt vmcnt(5)
L_big41:
    s_waitcnt vmcnt(10)
    buffer_load_dwordx4 v48, s[8:11], s97 offen nt lds
    s_add_u32 m0, s25, 13312
    s_xor_b32 s97, s24, 1582080
    s_cmp_lg_u32 s98, 0
    s_cbranch_scc1 L_big42
    s_waitcnt vmcnt(5)
L_big42:
    s_waitcnt vmcnt(10)
    buffer_load_dwordx4 v49, s[8:11], s97 offen nt lds
    s_lshr_b32 s28, s3, 0
    s_lshr_b32 s29, s4, 0
    s_xor_b32 s28, s28, s29
    s_and_b32 s28, s28, 3
    s_xor_b32 s28, s28, 1
    s_lshl_b32 s29, s28, 10
    s_add_u32 m0, s100, s29
    s_lshl_b32 s28, s28, 13
    s_add_u32 s30, s99, s28
    buffer_load_dwordx4 v58, s[20:23], s30 offen lds
    s_mov_b64 exec, 0
    s_call_b64 s[86:87], L_pad6
    s_mov_b64 exec, -1
    s_add_u32 m0, s25, 14336
    s_xor_b32 s97, s24, 1581312
    s_cmp_lg_u32 s98, 0
    s_cbranch_scc1 L_big43
    s_waitcnt vmcnt(6)
L_big43:
    s_waitcnt vmcnt(11)
    buffer_load_dwordx4 v50, s[8:11], s97 offen nt lds
    s_add_u32 m0, s25, 15360
    s_xor_b32 s97, s24, 1582336
    s_cmp_lg_u32 s98, 0
    s_cbranch_scc1 L_big44
    s_waitcnt vmcnt(5)
L_big44:
    s_waitcnt vmcnt(11)
    buffer_load_dwordx4 v51, s[8:11], s97 offen nt lds
    s_add_u32 m0, s25, 16384
    s_xor_b32 s97, s24, 528384
    s_cmp_lg_u32 s98, 0
    s_cbranch_scc1 L_big45
    s_waitcnt vmcnt(5)
L_big45:
    s_waitcnt vmcnt(11) lgkmcnt(0)
    buffer_load_dwordx4 v48, s[8:11], s97 offen nt lds
    s_add_u32 m0, s25, 17408
    s_xor_b32 s97, s24, 529408
    s_cmp_lg_u32 s98, 0
    s_cbranch_scc1 L_big46
    s_waitcnt vmcnt(5)
L_big46:
    s_waitcnt vmcnt(11)
    buffer_load_dwordx4 v49, s[8:11], s97 offen nt lds
    s_lshr_b32 s28, s3, 0
    s_lshr_b32 s29, s4, 0
    s_xor_b32 s28, s28, s29
    s_and_b32 s28, s28, 3
    s_xor_b32 s28, s28, 2
    s_lshl_b32 s29, s28, 10
    s_add_u32 m0, s100, s29
    s_lshl_b32 s28, s28, 13
    s_add_u32 s30, s99, s28
    buffer_load_dwordx4 v58, s[20:23], s30 offen lds
    v_and_b32 v63, 0x70, v1
    v_lshlrev_b32 v63, 1, v63
    global_load_dwordx2 v[60:61], v63, s[56:57] sc1
    s_mov_b64 exec, 0
    s_call_b64 s[86:87], L_pad7
    s_mov_b64 exec, -1
    s_add_u32 m0, s25, 18432
    s_xor_b32 s97, s24, 528640
    s_cmp_lg_u32 s98, 0
    s_cbranch_scc1 L_big47
    s_waitcnt vmcnt(7)
L_big47:
    s_waitcnt vmcnt(13)
    buffer_load_dwordx4 v50, s[8:11], s97 offen nt lds
    s_add_u32 m0, s25, 19456
    s_xor_b32 s97, s24, 529664
    s_cmp_lg_u32 s98, 0
    s_cbranch_scc1 L_big48
    s_waitcnt vmcnt(6)
L_big48:
    s_waitcnt vmcnt(13)
    buffer_load_dwordx4 v51, s[8:11], s97 offen nt lds
    s_add_u32 m0, s25, 20480
    s_xor_b32 s97, s24, 536576
    s_cmp_lg_u32 s98, 0
    s_cbranch_scc1 L_big49
    s_waitcnt vmcnt(6)
L_big49:
    s_waitcnt vmcnt(12)
    buffer_load_dwordx4 v48, s[8:11], s97 offen nt lds
    s_add_u32 m0, s25, 21504
    s_xor_b32 s97, s24, 537600
    s_cmp_lg_u32 s98, 0
    s_cbranch_scc1 L_big50
    s_waitcnt vmcnt(6)
L_big50:
    s_waitcnt vmcnt(12)
    buffer_load_dwordx4 v49, s[8:11], s97 offen nt lds
    ds_read_b128 a[128:131], v52 offset:0
    ds_read_b128 a[132:135], v53 offset:0
    ds_read_b128 a[136:139], v54 offset:0
    ds_read_b128 a[140:143], v55 offset:0
    v_xor_b32 v52, 0x110, v52
    v_xor_b32 v53, 0x110, v53
    v_xor_b32 v54, 0x110, v54
    v_xor_b32 v55, 0x110, v55
    ds_read_b128 a[144:147], v52 offset:0
    ds_read_b128 a[148:151], v53 offset:0
    ds_read_b128 a[152:155], v54 offset:0
    ds_read_b128 a[156:159], v55 offset:0
    v_mov_b32 v68, 158208
L_cnt_l:
    ds_read_b32 v69, v68
    s_sub_u32 s27, s27, 1
    s_cbranch_scc1 L_cnt_x
    s_waitcnt lgkmcnt(0)
    v_cmp_ne_u32 vcc, 4, v69
    s_cbranch_vccnz L_cnt_l
L_cnt_g:
    s_lshl_b32 s28, s6, 4
    s_add_u32 s28, s28, 157568
    v_mov_b32 v68, s28
    ds_read_b128 v[72:75], v68
    ds_read_b128 v[76:79], v68 offset:64
    s_waitcnt lgkmcnt(0)
    v_pk_add_f32 v[72:73], v[72:73], v[74:75]
    v_pk_add_f32 v[76:77], v[76:77], v[78:79]
    v_add_f32 v72, v72, v73
    v_add_f32 v76, v76, v77
    v_mul_f32 v73, 0x3b000000, v72
    v_mul_f32 v76, 0x3b000000, v76
    v_fma_f32 v76, -v73, v73, v76
    v_max_f32 v76, 0, v76
    v_add_f32 v76, 0x3727c5ac, v76
    v_rsq_f32 v76, v76
    s_nop 0
    v_mul_f32 v12, 0x3e0293ee, v76
    s_add_u32 m0, s25, 22528
    s_xor_b32 s97, s24, 536832
    s_cmp_lg_u32 s98, 0
    s_cbranch_scc1 L_big51
    s_waitcnt vmcnt(6)
L_big51:
    s_waitcnt vmcnt(12)
    buffer_load_dwordx4 v50, s[8:11], s97 offen nt lds
    s_lshr_b32 s28, s3, 0
    s_lshr_b32 s29, s4, 0
    s_xor_b32 s28, s28, s29
    s_and_b32 s28, s28, 3
    s_xor_b32 s28, s28, 3
    s_lshl_b32 s29, s28, 10
    s_add_u32 m0, s100, s29
    s_lshl_b32 s28, s28, 13
    s_add_u32 s30, s99, s28
    buffer_load_dwordx4 v58, s[20:23], s30 offen lds
    s_cmp_lg_u32 s3, 0
    s_cbranch_scc1 L_q1_skip
    v_lshrrev_b32 v68, 8, v1
    v_and_b32 v68, 1, v68
    v_lshlrev_b32 v68, 5, v68
    v_and_b32 v69, 0xc0, v1
    v_add_u32 v68, v68, v69
    v_and_b32 v69, 0x30, v1
    v_lshrrev_b32 v69, 1, v69
    v_add_u32 v68, v68, v69
    v_add_u32 v68, 156288, v68
    ds_read2_b64 v[24:27], v68 offset0:0 offset1:32
    ds_read2_b64 v[28:31], v68 offset0:64 offset1:96
    s_waitcnt lgkmcnt(1)
    v_pk_add_f32 v[24:25], v[24:25], v[26:27]
    s_waitcnt lgkmcnt(0)
L_pad1:
    s_cbranch_execz L_ret
    v_pk_add_f32 v[28:29], v[28:29], v[30:31]
    v_pk_add_f32 v[24:25], v[24:25], v[28:29]
    v_subrev_u32 v69, 156288, v68
    v_and_b32 v70, 0x3c, v69
    v_lshlrev_b32 v70, 2, v70
    v_add_u32 v70, 157696, v70
    ds_read_b128 v[32:35], v70
    ds_read_b128 v[36:39], v70 offset:16
    v_lshrrev_b32 v69, 6, v69
    v_lshlrev_b32 v69, 4, v69
    v_add_u32 v69, 157568, v69
    ds_read_b128 v[28:31], v69
    s_waitcnt lgkmcnt(0)
    v_add_f32 v28, v28, v29
    v_add_f32 v30, v30, v31
    v_add_f32 v28, v28, v30
    v_add_f32 v32, v32, v33
    v_add_f32 v34, v34, v35
    v_add_f32 v32, v32, v34
    v_add_f32 v36, v36, v37
    v_add_f32 v38, v38, v39
    v_add_f32 v36, v36, v38
    v_mul_f32 v28, 0x3b000000, v28
    v_fma_f32 v24, -v28, v32, v24
    v_fma_f32 v25, -v28, v36, v25
    v_cvt_pk_bf16_f32 v40, v24, v25
    v_and_b32 v41, 0xc0, v1
    v_lshlrev_b32 v41, 4, v41
    v_and_b32 v69, 0x100, v1
    v_add_u32 v41, v41, v69
    v_and_b32 v69, 0x30, v1
    v_lshrrev_b32 v69, 2, v69
    v_add_u32 v41, v41, v69
L_q1_skip:
    s_mov_b64 exec, 0
    s_call_b64 s[86:87], L_pad8
    s_mov_b64 exec, -1
    s_add_u32 m0, s25, 23552
    s_xor_b32 s97, s24, 537856
    s_cmp_lg_u32 s98, 0
    s_cbranch_scc1 L_big52
    s_waitcnt vmcnt(5)
L_big52:
    s_waitcnt vmcnt(13)
    buffer_load_dwordx4 v51, s[8:11], s97 offen nt lds
    s_add_u32 m0, s25, 24576
    s_xor_b32 s97, s24, 1576960
    s_cmp_lg_u32 s98, 0
    s_cbranch_scc1 L_big53
    s_waitcnt vmcnt(5)
L_big53:
    s_waitcnt vmcnt(12)
    buffer_load_dwordx4 v48, s[8:11], s97 offen nt lds
    s_add_u32 m0, s25, 25600
    s_xor_b32 s97, s24, 1577984
    s_cmp_lg_u32 s98, 0
    s_cbranch_scc1 L_big54
    s_waitcnt vmcnt(5)
L_big54:
    s_waitcnt vmcnt(12)
    buffer_load_dwordx4 v49, s[8:11], s97 offen nt lds
    ds_read_b128 a[176:179], v52 offset:4096
    ds_read_b128 a[180:183], v53 offset:4096
    ds_read_b128 a[184:187], v54 offset:4096
    ds_read_b128 a[188:191], v55 offset:4096
    v_xor_b32 v52, 0x110, v52
    v_xor_b32 v53, 0x110, v53
    v_xor_b32 v54, 0x110, v54
    v_xor_b32 v55, 0x110, v55
    ds_read_b128 a[160:163], v52 offset:4096
    ds_read_b128 a[164:167], v53 offset:4096
    ds_read_b128 a[168:171], v54 offset:4096
    ds_read_b128 a[172:175], v55 offset:4096
    s_mov_b64 exec, 0
    s_call_b64 s[86:87], L_pad9
    s_mov_b64 exec, -1
    s_add_u32 m0, s25, 26624
    s_xor_b32 s97, s24, 1577216
    s_cmp_lg_u32 s98, 0
    s_cbranch_scc1 L_big55
    s_waitcnt vmcnt(5)
L_big55:
    s_waitcnt vmcnt(12)
    buffer_load_dwordx4 v50, s[8:11], s97 offen nt lds
    s_add_u32 m0, s25, 27648
    s_xor_b32 s97, s24, 1578240
    s_cmp_lg_u32 s98, 0
    s_cbranch_scc1 L_big56
    s_waitcnt vmcnt(5)
L_big56:
    s_waitcnt vmcnt(12)
    buffer_load_dwordx4 v51, s[8:11], s97 offen nt lds
    s_add_u32 m0, s25, 28672
    s_xor_b32 s97, s24, 1585152
    s_cmp_lg_u32 s98, 0
    s_cbranch_scc1 L_big57
    s_waitcnt vmcnt(4)
L_big57:
    s_waitcnt vmcnt(10)
    buffer_load_dwordx4 v48, s[8:11], s97 offen nt lds
    s_mov_b32 s20, s52
    s_and_b32 s21, s53, 0xffff
    s_mov_b32 s22, 1835008
    s_mov_b32 s23, 0x20000
    v_bfe_u32 v58, v1, 5, 4
    v_and_b32 v59, 16, v1
    v_lshl_add_u32 v58, v58, 10, v59
    v_lshrrev_b32 v59, 9, v1
    v_lshl_add_u32 v58, v59, 15, v58
    s_lshl_b32 s28, s3, 16
    s_mul_i32 s29, s4, 229376
    s_add_u32 s22, s29, 229376
    s_add_u32 s28, s28, s29
    s_xor_b32 s29, s5, 0
    s_lshl_b32 s29, s29, 5
    s_add_u32 s99, s28, s29
    s_lshl_b32 s100, s3, 11
    s_add_u32 s100, s100, 131072
    s_lshr_b32 s28, s3, 0
    s_lshr_b32 s29, s4, 0
    s_xor_b32 s28, s28, s29
    s_and_b32 s28, s28, 1
    s_xor_b32 s28, s28, 1
    s_lshl_b32 s29, s28, 10
    s_add_u32 m0, s100, s29
    s_lshl_b32 s28, s28, 14
    s_add_u32 s30, s99, s28
    buffer_load_dwordx4 v58, s[20:23], s30 offen lds
    s_add_u32 m0, s25, 29696
    s_xor_b32 s97, s24, 1586176
    s_cmp_lg_u32 s98, 0
    s_cbranch_scc1 L_big58
    s_waitcnt vmcnt(5)
L_big58:
    s_waitcnt vmcnt(11)
    buffer_load_dwordx4 v49, s[8:11], s97 offen nt lds
    s_waitcnt vmcnt(14)
L_init_w:
    v_bfe_u32 v13, v61, 16, 8
    v_cmp_ne_u32 vcc, 32, v13
    s_cbranch_vccnz L_init_r
L_init_g:
    v_readlane_b32 s28, v60, s4
    v_readlane_b32 s29, v61, s4
    s_lshr_b32 s30, s29, 24
    s_cmp_gt_u32 s30, 16
    s_cselect_b32 s30, 0, 8192
    v_cmp_lt_u32 vcc, 0x10ffffff, v61
    s_add_u32 s92, s30, 442368
    s_and_b32 s31, vcc_lo, 0xff
    s_bcnt1_i32_b32 s32, s31
    s_cmp_eq_u32 s32, 4
    s_cselect_b32 s31, s31, 0xf0
    s_lshr_b32 s34, s5, 2
    s_lshr_b32 s32, s31, s34
    s_and_b32 s32, s32, 1
    s_cselect_b32 s33, 0, 0xff
    s_cselect_b32 s32, 0, 8192
    s_xor_b32 s33, s31, s33
    s_bfm_b32 s34, s34, 0
    s_and_b32 s33, s33, s34
    s_bcnt1_i32_b32 s33, s33
    s_lshl_b32 s33, s33, 14
    s_add_u32 s32, s32, s33
    s_add_u32 s76, s76, s32
    s_add_u32 s75, s75, s32
    s_lshr_b32 s32, s31, s4
    s_and_b32 s32, s32, 1
    s_cselect_b32 s33, 0, 0xff
    s_xor_b32 s31, s31, s33
    s_bfm_b32 s33, s4, 0
    s_and_b32 s31, s31, s33
    s_bcnt1_i32_b32 s31, s31
    s_lshl_b32 s31, s31, 6
    s_lshl_b32 s32, s32, 12
    s_add_u32 s32, s32, s30
    s_add_u32 s67, s67, s32
    s_xor_b32 s68, s67, 4096
    s_add_u32 s69, s69, s32
    s_xor_b32 s70, s69, 4096
    s_add_u32 s31, s31, s32
    s_add_u32 s31, s31, s65
    s_add_u32 s65, s31, 262144
    s_xor_b32 s101, s65, 8192
    s_add_u32 s66, s31, 524288
    s_xor_b32 s95, s66, 8192
    s_mov_b32 s96, 4194304
    s_and_b32 s29, s29, 0xffff
    s_mul_i32 s30, s82, 6
    s_lshl_b64 s[30:31], 32, s30
    s_cmp_lg_u64 s[28:29], s[30:31]
    s_cselect_b32 s26, 1, 0
    s_cmp_lg_u32 s26, 0
    s_cselect_b32 s93, 4194304, s60
    s_cselect_b32 s94, s60, 4194304
    s_cmp_lg_u32 s3, 0
    s_cbranch_scc1 L_pq_skip
    s_add_u32 s28, s73, 327680
    s_mov_b32 exec_hi, 0
    s_cmp_lg_u32 s26, 0
    s_cbranch_scc1 L_slow59
    buffer_store_dword v40, v41, s[16:19], s28 offen
L_slow59b:
    s_mov_b64 exec, -1
L_pq_skip:
    s_mov_b64 exec, 0
    s_call_b64 s[86:87], L_pad10
    s_mov_b64 exec, -1
    s_add_u32 m0, s25, 30720
    s_xor_b32 s97, s24, 1585408
    s_cmp_lg_u32 s98, 0
    s_cbranch_scc1 L_big60
    s_waitcnt vmcnt(5)
L_big60:
    s_waitcnt vmcnt(11)
    buffer_load_dwordx4 v50, s[8:11], s97 offen nt lds
    s_add_u32 m0, s25, 31744
    s_xor_b32 s97, s24, 1586432
    s_cmp_lg_u32 s98, 0
    s_cbranch_scc1 L_big61
    s_waitcnt vmcnt(5)
L_big61:
    s_waitcnt vmcnt(11)
    buffer_load_dwordx4 v51, s[8:11], s97 offen nt lds
    s_add_u32 m0, s25, 0
    s_xor_b32 s97, s24, 0
    s_cmp_lg_u32 s98, 0
    s_cbranch_scc1 L_big62
    s_waitcnt vmcnt(6)
L_big62:
    s_waitcnt vmcnt(11) lgkmcnt(0)
    buffer_load_dwordx4 v56, s[12:15], s97 offen nt lds
    s_add_u32 m0, s25, 1024
    s_xor_b32 s97, s24, 1024
    s_cmp_lg_u32 s98, 0
    s_cbranch_scc1 L_big63
    s_waitcnt vmcnt(6)
L_big63:
    s_waitcnt vmcnt(10)
    buffer_load_dwordx4 v57, s[12:15], s97 offen nt lds
    s_waitcnt vmcnt(12)
    v_and_b32 v58, 0x300, v1
    v_lshlrev_b32 v58, 2, v58
    v_and_b32 v59, 0xf0, v1
    v_lshrrev_b32 v59, 1, v59
    v_add_u32 v58, v58, v59
    v_add_u32 v58, s83, v58
    ds_read_b64_tr_b16 v[96:97], v58 offset:0
    ds_read_b64_tr_b16 v[98:99], v58 offset:128
    ds_read_b64_tr_b16 v[100:101], v58 offset:256
    ds_read_b64_tr_b16 v[102:103], v58 offset:384
    ds_read_b64_tr_b16 v[104:105], v58 offset:512
    ds_read_b64_tr_b16 v[106:107], v58 offset:640
    ds_read_b64_tr_b16 v[108:109], v58 offset:768
    ds_read_b64_tr_b16 v[110:111], v58 offset:896
    s_mov_b64 exec, 0
    s_call_b64 s[86:87], L_pad11
    s_mov_b64 exec, -1
    s_add_u32 m0, s25, 2048
    s_xor_b32 s97, s24, 256
    s_cmp_lg_u32 s98, 0
    s_cbranch_scc1 L_big64
    s_waitcnt vmcnt(6)
L_big64:
    s_waitcnt vmcnt(10)
    buffer_load_dwordx4 v56, s[12:15], s97 offen nt lds
    s_add_u32 m0, s25, 3072
    s_xor_b32 s97, s24, 1280
    s_cmp_lg_u32 s98, 0
    s_cbranch_scc1 L_big65
    s_waitcnt vmcnt(5)
L_big65:
    s_waitcnt vmcnt(10)
    buffer_load_dwordx4 v57, s[12:15], s97 offen nt lds
    s_mov_b32 s20, s48
    s_and_b32 s21, s49, 0xffff
    s_mov_b32 s22, 1835008
    s_mov_b32 s23, 0x20000
    s_mov_b32 s22, s89
    v_mul_u32_u24 v58, 224, v1
    s_mul_i32 s28, s3, 458752
    s_mul_i32 s29, s4, 448
    s_add_u32 s28, s28, s29
    s_lshl_b32 s29, s88, 4
    s_add_u32 s99, s28, s29
    s_mov_b32 s100, s83
    s_waitcnt lgkmcnt(0)
    s_lshr_b32 s28, s3, 0
    s_lshr_b32 s29, s4, 0
    s_xor_b32 s28, s28, s29
    s_and_b32 s28, s28, 1
    s_xor_b32 s28, s28, 0
    s_lshl_b32 s29, s28, 10
    s_add_u32 m0, s100, s29
    s_and_b32 s28, s28, 1
    s_mul_i32 s28, s28, 229376
    s_add_u32 s30, s99, s28
    s_mov_b32 exec_lo, 0xffffffff
    s_mov_b32 exec_hi, 0x0
    buffer_load_dwordx4 v58, s[20:23], s30 offen lds
    s_mov_b64 exec, -1
    s_add_u32 m0, s25, 4096
    s_xor_b32 s97, s24, 8192
    s_cmp_lg_u32 s98, 0
    s_cbranch_scc1 L_big66
    s_waitcnt vmcnt(6)
L_big66:
    s_waitcnt vmcnt(11)
    buffer_load_dwordx4 v56, s[12:15], s97 offen nt lds
    s_add_u32 m0, s25, 5120
    s_xor_b32 s97, s24, 9216
    s_cmp_lg_u32 s98, 0
    s_cbranch_scc1 L_big67
    s_waitcnt vmcnt(6)
L_big67:
    s_waitcnt vmcnt(11)
    buffer_load_dwordx4 v57, s[12:15], s97 offen nt lds
    ds_read_b128 a[192:195], v52 offset:16384
    ds_read_b128 a[196:199], v53 offset:16384
    ds_read_b128 a[200:203], v54 offset:16384
    ds_read_b128 a[204:207], v55 offset:16384
    v_xor_b32 v52, 0x110, v52
    v_xor_b32 v53, 0x110, v53
    v_xor_b32 v54, 0x110, v54
    v_xor_b32 v55, 0x110, v55
    ds_read_b128 a[208:211], v52 offset:16384
    ds_read_b128 a[212:215], v53 offset:16384
    ds_read_b128 a[216:219], v54 offset:16384
    ds_read_b128 a[220:223], v55 offset:16384
    s_mov_b64 exec, 0
    s_call_b64 s[86:87], L_pad12
    s_mov_b64 exec, -1
    s_add_u32 m0, s25, 6144
    s_xor_b32 s97, s24, 8448
    s_cmp_lg_u32 s98, 0
    s_cbranch_scc1 L_big68
    s_waitcnt vmcnt(6)
L_big68:
    s_waitcnt vmcnt(11)
    buffer_load_dwordx4 v56, s[12:15], s97 offen nt lds
    s_add_u32 m0, s25, 7168
    s_xor_b32 s97, s24, 9472
    s_cmp_lg_u32 s98, 0
    s_cbranch_scc1 L_big69
    s_waitcnt vmcnt(6)
L_big69:
    s_waitcnt vmcnt(10)
    buffer_load_dwordx4 v57, s[12:15], s97 offen nt lds
    s_add_u32 m0, s25, 8192
    s_xor_b32 s97, s24, 1048576
    s_cmp_lg_u32 s98, 0
    s_cbranch_scc1 L_big70
    s_waitcnt vmcnt(6)
L_big70:
    s_waitcnt vmcnt(10)
    buffer_load_dwordx4 v56, s[12:15], s97 offen nt lds
    s_add_u32 m0, s25, 9216
    s_xor_b32 s97, s24, 1049600
    s_cmp_lg_u32 s98, 0
    s_cbranch_scc1 L_big71
    s_waitcnt vmcnt(6)
L_big71:
    s_waitcnt vmcnt(10)
    buffer_load_dwordx4 v57, s[12:15], s97 offen nt lds
    s_lshr_b32 s28, s3, 0
    s_lshr_b32 s29, s4, 0
    s_xor_b32 s28, s28, s29
    s_and_b32 s28, s28, 1
    s_xor_b32 s28, s28, 0
    s_lshl_b32 s29, s28, 10
    s_add_u32 m0, s100, s29
    s_and_b32 s28, s28, 1
    s_mul_i32 s28, s28, 229376
    s_add_u32 s30, s99, s28
    s_mov_b32 exec_lo, 0x0
    s_mov_b32 exec_hi, 0xffffffff
    buffer_load_dwordx4 v58, s[20:23], s30 offen lds
    s_mov_b64 exec, -1
    ds_read_b128 a[240:243], v52 offset:20480
    ds_read_b128 a[244:247], v53 offset:20480
    ds_read_b128 a[248:251], v54 offset:20480
    ds_read_b128 a[252:255], v55 offset:20480
    v_xor_b32 v52, 0x110, v52
    v_xor_b32 v53, 0x110, v53
    v_xor_b32 v54, 0x110, v54
    v_xor_b32 v55, 0x110, v55
    ds_read_b128 a[224:227], v52 offset:20480
    ds_read_b128 a[228:231], v53 offset:20480
    ds_read_b128 a[232:235], v54 offset:20480
    ds_read_b128 a[236:239], v55 offset:20480
    s_mov_b64 exec, 0
    s_call_b64 s[86:87], L_pad13
    s_mov_b64 exec, -1
    s_add_u32 m0, s25, 10240
    s_xor_b32 s97, s24, 1048832
    s_cmp_lg_u32 s98, 0
    s_cbranch_scc1 L_big72
    s_waitcnt vmcnt(6)
L_big72:
    s_waitcnt vmcnt(11)
    buffer_load_dwordx4 v56, s[12:15], s97 offen nt lds
    s_add_u32 m0, s25, 11264
    s_xor_b32 s97, s24, 1049856
    s_cmp_lg_u32 s98, 0
    s_cbranch_scc1 L_big73
    s_waitcnt vmcnt(6)
L_big73:
    s_waitcnt vmcnt(11)
    buffer_load_dwordx4 v57, s[12:15], s97 offen nt lds
    s_add_u32 m0, s25, 12288
    s_xor_b32 s97, s24, 1056768
    s_cmp_lg_u32 s98, 0
    s_cbranch_scc1 L_big74
    s_waitcnt vmcnt(6)
L_big74:
    s_waitcnt vmcnt(11)
    buffer_load_dwordx4 v56, s[12:15], s97 offen nt lds
    s_add_u32 m0, s25, 13312
    s_xor_b32 s97, s24, 1057792
    s_cmp_lg_u32 s98, 0
    s_cbranch_scc1 L_big75
    s_waitcnt vmcnt(6)
L_big75:
    s_waitcnt vmcnt(11)
    buffer_load_dwordx4 v57, s[12:15], s97 offen nt lds
    ds_read_b64_tr_b16 v[128:129], v2 offset:0
    ds_read_b64_tr_b16 v[136:137], v3 offset:0
    ds_read_b64_tr_b16 v[144:145], v4 offset:0
    ds_read_b64_tr_b16 v[152:153], v5 offset:0
    ds_read_b64_tr_b16 v[160:161], v6 offset:0
    ds_read_b64_tr_b16 v[168:169], v7 offset:0
    ds_read_b64_tr_b16 v[176:177], v8 offset:0
    ds_read_b64_tr_b16 v[184:185], v9 offset:0
    s_mov_b64 exec, 0
    s_call_b64 s[86:87], L_pad14
    s_mov_b64 exec, -1
    s_add_u32 m0, s25, 14336
    s_xor_b32 s97, s24, 1057024
    s_cmp_lg_u32 s98, 0
    s_cbranch_scc1 L_big76
    s_waitcnt vmcnt(6)
L_big76:
    s_waitcnt vmcnt(10)
    buffer_load_dwordx4 v56, s[12:15], s97 offen nt lds
    s_add_u32 m0, s25, 15360
    s_xor_b32 s97, s24, 1058048
    s_cmp_lg_u32 s98, 0
    s_cbranch_scc1 L_big77
    s_waitcnt vmcnt(6)
L_big77:
    s_waitcnt vmcnt(10)
    buffer_load_dwordx4 v57, s[12:15], s97 offen nt lds
    s_lshr_b32 s28, s3, 0
    s_lshr_b32 s29, s4, 0
    s_xor_b32 s28, s28, s29
    s_and_b32 s28, s28, 1
    s_xor_b32 s28, s28, 1
    s_lshl_b32 s29, s28, 10
    s_add_u32 m0, s100, s29
    s_and_b32 s28, s28, 1
    s_mul_i32 s28, s28, 229376
    s_add_u32 s30, s99, s28
    s_mov_b32 exec_lo, 0xffffffff
    s_mov_b32 exec_hi, 0x0
    buffer_load_dwordx4 v58, s[20:23], s30 offen lds
    s_mov_b64 exec, -1
    s_add_u32 m0, s25, 16384
    s_xor_b32 s97, s24, 4096
    s_cmp_lg_u32 s98, 0
    s_cbranch_scc1 L_big78
    s_waitcnt vmcnt(6)
L_big78:
    s_waitcnt vmcnt(11) lgkmcnt(0)
    buffer_load_dwordx4 v56, s[12:15], s97 offen nt lds
    s_add_u32 m0, s25, 17408
    s_xor_b32 s97, s24, 5120
    s_cmp_lg_u32 s98, 0
    s_cbranch_scc1 L_big79
    s_waitcnt vmcnt(6)
L_big79:
    s_waitcnt vmcnt(11)
    buffer_load_dwordx4 v57, s[12:15], s97 offen nt lds
    ds_read_b64_tr_b16 v[130:131], v2 offset:4096
    ds_read_b64_tr_b16 v[138:139], v3 offset:4096
    ds_read_b64_tr_b16 v[146:147], v4 offset:4096
    ds_read_b64_tr_b16 v[154:155], v5 offset:4096
    ds_read_b64_tr_b16 v[162:163], v6 offset:4096
    ds_read_b64_tr_b16 v[170:171], v7 offset:4096
    ds_read_b64_tr_b16 v[178:179], v8 offset:4096
    ds_read_b64_tr_b16 v[186:187], v9 offset:4096
    s_mov_b64 exec, 0
    s_call_b64 s[86:87], L_pad15
    s_mov_b64 exec, -1
    s_add_u32 m0, s25, 18432
    s_xor_b32 s97, s24, 4352
    s_cmp_lg_u32 s98, 0
    s_cbranch_scc1 L_big80
    s_waitcnt vmcnt(6)
L_big80:
    s_waitcnt vmcnt(11)
    buffer_load_dwordx4 v56, s[12:15], s97 offen nt lds
    s_add_u32 m0, s25, 19456
    s_xor_b32 s97, s24, 5376
    s_cmp_lg_u32 s98, 0
    s_cbranch_scc1 L_big81
    s_waitcnt vmcnt(6)
L_big81:
    s_waitcnt vmcnt(11)
    buffer_load_dwordx4 v57, s[12:15], s97 offen nt lds
    s_add_u32 m0, s25, 20480
    s_xor_b32 s97, s24, 12288
    s_cmp_lg_u32 s98, 0
    s_cbranch_scc1 L_big82
    s_waitcnt vmcnt(6)
L_big82:
    s_waitcnt vmcnt(10)
    buffer_load_dwordx4 v56, s[12:15], s97 offen nt lds
    s_add_u32 m0, s25, 21504
    s_xor_b32 s97, s24, 13312
    s_cmp_lg_u32 s98, 0
    s_cbranch_scc1 L_big83
    s_waitcnt vmcnt(6)
L_big83:
    s_waitcnt vmcnt(10)
    buffer_load_dwordx4 v57, s[12:15], s97 offen nt lds
    s_lshr_b32 s28, s3, 0
    s_lshr_b32 s29, s4, 0
    s_xor_b32 s28, s28, s29
    s_and_b32 s28, s28, 1
    s_xor_b32 s28, s28, 1
    s_lshl_b32 s29, s28, 10
    s_add_u32 m0, s100, s29
    s_and_b32 s28, s28, 1
    s_mul_i32 s28, s28, 229376
    s_add_u32 s30, s99, s28
    s_mov_b32 exec_lo, 0x0
    s_mov_b32 exec_hi, 0xffffffff
    buffer_load_dwordx4 v58, s[20:23], s30 offen lds
    s_mov_b64 exec, -1
    ds_read_b64_tr_b16 v[132:133], v2 offset:8192
    ds_read_b64_tr_b16 v[140:141], v3 offset:8192
    ds_read_b64_tr_b16 v[148:149], v4 offset:8192
    ds_read_b64_tr_b16 v[156:157], v5 offset:8192
    ds_read_b64_tr_b16 v[164:165], v6 offset:8192
    ds_read_b64_tr_b16 v[172:173], v7 offset:8192
    ds_read_b64_tr_b16 v[180:181], v8 offset:8192
    ds_read_b64_tr_b16 v[188:189], v9 offset:8192
    s_add_u32 m0, s25, 22528
    s_xor_b32 s97, s24, 12544
    s_cmp_lg_u32 s98, 0
    s_cbranch_scc1 L_big84
    s_waitcnt vmcnt(6)
L_big84:
    s_waitcnt vmcnt(11)
    buffer_load_dwordx4 v56, s[12:15], s97 offen nt lds
    s_add_u32 m0, s25, 23552
    s_xor_b32 s97, s24, 13568
    s_cmp_lg_u32 s98, 0
    s_cbranch_scc1 L_big85
    s_waitcnt vmcnt(6)
L_big85:
    s_waitcnt vmcnt(11)
    buffer_load_dwordx4 v57, s[12:15], s97 offen nt lds
    s_add_u32 m0, s25, 24576
    s_xor_b32 s97, s24, 1052672
    s_cmp_lg_u32 s98, 0
    s_cbranch_scc1 L_big86
    s_waitcnt vmcnt(6)
L_big86:
    s_waitcnt vmcnt(11)
    buffer_load_dwordx4 v56, s[12:15], s97 offen nt lds
    s_add_u32 m0, s25, 25600
    s_xor_b32 s97, s24, 1053696
    s_cmp_lg_u32 s98, 0
    s_cbranch_scc1 L_big87
    s_waitcnt vmcnt(6)
L_big87:
    s_waitcnt vmcnt(11)
    buffer_load_dwordx4 v57, s[12:15], s97 offen nt lds
    ds_read_b64_tr_b16 v[134:135], v2 offset:12288
    ds_read_b64_tr_b16 v[142:143], v3 offset:12288
    ds_read_b64_tr_b16 v[150:151], v4 offset:12288
    ds_read_b64_tr_b16 v[158:159], v5 offset:12288
    ds_read_b64_tr_b16 v[166:167], v6 offset:12288
    ds_read_b64_tr_b16 v[174:175], v7 offset:12288
    ds_read_b64_tr_b16 v[182:183], v8 offset:12288
    ds_read_b64_tr_b16 v[190:191], v9 offset:12288
    s_add_u32 m0, s25, 26624
    s_xor_b32 s97, s24, 1052928
    s_cmp_lg_u32 s98, 0
    s_cbranch_scc1 L_big88
    s_waitcnt vmcnt(6)
L_big88:
    s_waitcnt vmcnt(10)
    buffer_load_dwordx4 v56, s[12:15], s97 offen nt lds
    s_add_u32 m0, s25, 27648
    s_xor_b32 s97, s24, 1053952
    s_cmp_lg_u32 s98, 0
    s_cbranch_scc1 L_big89
    s_waitcnt vmcnt(6)
L_big89:
    s_waitcnt vmcnt(10)
    buffer_load_dwordx4 v57, s[12:15], s97 offen nt lds
    s_mov_b32 s20, s50
    s_and_b32 s21, s51, 0xffff
    s_mov_b32 s22, 1835008
    s_mov_b32 s23, 0x20000
    s_mov_b32 s22, s89
    v_mul_u32_u24 v58, 224, v1
    s_mul_i32 s28, s3, 458752
    s_mul_i32 s29, s4, 448
    s_add_u32 s28, s28, s29
    s_lshl_b32 s29, s88, 4
    s_add_u32 s99, s28, s29
    s_mov_b32 s100, s83
    s_waitcnt lgkmcnt(0)
    s_lshr_b32 s28, s3, 0
    s_lshr_b32 s29, s4, 0
    s_xor_b32 s28, s28, s29
    s_and_b32 s28, s28, 1
    s_xor_b32 s28, s28, 2
    s_lshl_b32 s29, s28, 10
    s_add_u32 m0, s100, s29
    s_and_b32 s28, s28, 1
    s_mul_i32 s28, s28, 229376
    s_add_u32 s30, s99, s28
    s_mov_b32 exec_lo, 0xffffffff
    s_mov_b32 exec_hi, 0x0
    buffer_load_dwordx4 v58, s[20:23], s30 offen lds
    s_mov_b64 exec, -1
    s_add_u32 m0, s25, 28672
    s_xor_b32 s97, s24, 1060864
    s_cmp_lg_u32 s98, 0
    s_cbranch_scc1 L_big90
    s_waitcnt vmcnt(6)
L_big90:
    s_waitcnt vmcnt(11)
    buffer_load_dwordx4 v56, s[12:15], s97 offen nt lds
    s_add_u32 m0, s25, 29696
    s_xor_b32 s97, s24, 1061888
    s_cmp_lg_u32 s98, 0
    s_cbranch_scc1 L_big91
    s_waitcnt vmcnt(6)
L_big91:
    s_waitcnt vmcnt(11)
    buffer_load_dwordx4 v57, s[12:15], s97 offen nt lds
    ds_read_b64_tr_b16 v[192:193], v2 offset:16384
    ds_read_b64_tr_b16 v[200:201], v3 offset:16384
    ds_read_b64_tr_b16 v[208:209], v4 offset:16384
    ds_read_b64_tr_b16 v[216:217], v5 offset:16384
    ds_read_b64_tr_b16 v[224:225], v6 offset:16384
    ds_read_b64_tr_b16 v[232:233], v7 offset:16384
    ds_read_b64_tr_b16 v[240:241], v8 offset:16384
    ds_read_b64_tr_b16 v[248:249], v9 offset:16384
    s_add_u32 s33, s74, 327680
    buffer_load_dwordx4 v[32:35], v1, s[16:19], s33 offen sc1
    s_add_u32 m0, s25, 30720
    s_xor_b32 s97, s24, 1061120
    s_cmp_lg_u32 s98, 0
    s_cbranch_scc1 L_big92
    s_waitcnt vmcnt(7)
L_big92:
    s_waitcnt vmcnt(12)
    buffer_load_dwordx4 v56, s[12:15], s97 offen nt lds
    s_add_u32 m0, s25, 31744
    s_xor_b32 s97, s24, 1062144
    s_cmp_lg_u32 s98, 0
    s_cbranch_scc1 L_big93
    s_waitcnt vmcnt(7)
L_big93:
    s_waitcnt vmcnt(12)
    buffer_load_dwordx4 v57, s[12:15], s97 offen nt lds
    s_add_u32 m0, s25, 0
    s_xor_b32 s97, s24, 524288
    s_cmp_lg_u32 s98, 0
    s_cbranch_scc1 L_big94
    s_waitcnt vmcnt(7)
L_big94:
    s_waitcnt vmcnt(11)
    buffer_load_dwordx4 v56, s[12:15], s97 offen nt lds
    s_add_u32 m0, s25, 1024
    s_xor_b32 s97, s24, 525312
    s_cmp_lg_u32 s98, 0
    s_cbranch_scc1 L_big95
    s_waitcnt vmcnt(7)
L_big95:
    s_waitcnt vmcnt(11)
    buffer_load_dwordx4 v57, s[12:15], s97 offen nt lds
    s_lshr_b32 s28, s3, 0
    s_lshr_b32 s29, s4, 0
    s_xor_b32 s28, s28, s29
    s_and_b32 s28, s28, 1
    s_xor_b32 s28, s28, 2
    s_lshl_b32 s29, s28, 10
    s_add_u32 m0, s100, s29
    s_and_b32 s28, s28, 1
    s_mul_i32 s28, s28, 229376
    s_add_u32 s30, s99, s28
    s_mov_b32 exec_lo, 0x0
    s_mov_b32 exec_hi, 0xffffffff
    buffer_load_dwordx4 v58, s[20:23], s30 offen lds
    s_mov_b64 exec, -1
    ds_read_b64_tr_b16 v[194:195], v2 offset:20480
    ds_read_b64_tr_b16 v[202:203], v3 offset:20480
    ds_read_b64_tr_b16 v[210:211], v4 offset:20480
    ds_read_b64_tr_b16 v[218:219], v5 offset:20480
    ds_read_b64_tr_b16 v[226:227], v6 offset:20480
    ds_read_b64_tr_b16 v[234:235], v7 offset:20480
    ds_read_b64_tr_b16 v[242:243], v8 offset:20480
    ds_read_b64_tr_b16 v[250:251], v9 offset:20480
    s_add_u32 m0, s25, 2048
    s_xor_b32 s97, s24, 524544
    s_cmp_lg_u32 s98, 0
    s_cbranch_scc1 L_big96
    s_waitcnt vmcnt(7)
L_big96:
    s_waitcnt vmcnt(12)
    buffer_load_dwordx4 v56, s[12:15], s97 offen nt lds
    s_add_u32 m0, s25, 3072
    s_xor_b32 s97, s24, 525568
    s_cmp_lg_u32 s98, 0
    s_cbranch_scc1 L_big97
    s_waitcnt vmcnt(7)
L_big97:
    s_waitcnt vmcnt(12)
    buffer_load_dwordx4 v57, s[12:15], s97 offen nt lds
    s_add_u32 m0, s25, 4096
    s_xor_b32 s97, s24, 532480
    s_cmp_lg_u32 s98, 0
    s_cbranch_scc1 L_big98
    s_waitcnt vmcnt(6)
L_big98:
    s_waitcnt vmcnt(12) lgkmcnt(0)
    buffer_load_dwordx4 v56, s[12:15], s97 offen nt lds
    s_add_u32 m0, s25, 5120
    s_xor_b32 s97, s24, 533504
    s_cmp_lg_u32 s98, 0
    s_cbranch_scc1 L_big99
    s_waitcnt vmcnt(6)
L_big99:
    s_waitcnt vmcnt(12)
    buffer_load_dwordx4 v57, s[12:15], s97 offen nt lds
    ds_read_b64_tr_b16 v[196:197], v2 offset:24576
    ds_read_b64_tr_b16 v[204:205], v3 offset:24576
    ds_read_b64_tr_b16 v[212:213], v4 offset:24576
    ds_read_b64_tr_b16 v[220:221], v5 offset:24576
    ds_read_b64_tr_b16 v[228:229], v6 offset:24576
    ds_read_b64_tr_b16 v[236:237], v7 offset:24576
    ds_read_b64_tr_b16 v[244:245], v8 offset:24576
    ds_read_b64_tr_b16 v[252:253], v9 offset:24576
    s_add_u32 m0, s25, 6144
    s_xor_b32 s97, s24, 532736
    s_cmp_lg_u32 s98, 0
    s_cbranch_scc1 L_big100
    s_waitcnt vmcnt(6)
L_big100:
    s_waitcnt vmcnt(11)
    buffer_load_dwordx4 v56, s[12:15], s97 offen nt lds
    s_add_u32 m0, s25, 7168
L_pad2:
    s_cbranch_execz L_ret
    s_xor_b32 s97, s24, 533760
    s_cmp_lg_u32 s98, 0
    s_cbranch_scc1 L_big101
    s_waitcnt vmcnt(6)
L_big101:
    s_waitcnt vmcnt(11)
    buffer_load_dwordx4 v57, s[12:15], s97 offen nt lds
    s_lshr_b32 s28, s3, 0
    s_lshr_b32 s29, s4, 0
    s_xor_b32 s28, s28, s29
    s_and_b32 s28, s28, 1
    s_xor_b32 s28, s28, 3
    s_lshl_b32 s29, s28, 10
    s_add_u32 m0, s100, s29
    s_and_b32 s28, s28, 1
    s_mul_i32 s28, s28, 229376
    s_add_u32 s30, s99, s28
    s_mov_b32 exec_lo, 0xffffffff
    s_mov_b32 exec_hi, 0x0
    buffer_load_dwordx4 v58, s[20:23], s30 offen lds
    s_mov_b64 exec, -1
    s_add_u32 m0, s25, 8192
    s_xor_b32 s97, s24, 1572864
    s_cmp_lg_u32 s98, 0
    s_cbranch_scc1 L_big102
    s_waitcnt vmcnt(6)
L_big102:
    s_waitcnt vmcnt(11)
    buffer_load_dwordx4 v56, s[12:15], s97 offen nt lds
    s_add_u32 m0, s25, 9216
    s_xor_b32 s97, s24, 1573888
    s_cmp_lg_u32 s98, 0
    s_cbranch_scc1 L_big103
    s_waitcnt vmcnt(6)
L_big103:
    s_waitcnt vmcnt(11)
    buffer_load_dwordx4 v57, s[12:15], s97 offen nt lds
    ds_read_b64_tr_b16 v[198:199], v2 offset:28672
    ds_read_b64_tr_b16 v[206:207], v3 offset:28672
    ds_read_b64_tr_b16 v[214:215], v4 offset:28672
    ds_read_b64_tr_b16 v[222:223], v5 offset:28672
    ds_read_b64_tr_b16 v[230:231], v6 offset:28672
    ds_read_b64_tr_b16 v[238:239], v7 offset:28672
    ds_read_b64_tr_b16 v[246:247], v8 offset:28672
    ds_read_b64_tr_b16 v[254:255], v9 offset:28672
    s_waitcnt vmcnt(14) lgkmcnt(0)
L_q1_w:
    v_max3_u32 v13, v32, v33, v34
    v_max_u32 v13, v13, v35
    v_cmp_eq_u32 vcc, 0xffbfffbf, v13
    s_cbranch_vccnz L_q1_r
L_q1_g:
    v_and_b32 v13, 0xc0, v1
    v_xor_b32 v44, 0, v13
    v_xor_b32 v45, 64, v13
    v_xor_b32 v46, 128, v13
    v_xor_b32 v47, 192, v13
    v_add_u32 v44, -1, v44
    v_add_u32 v45, -1, v45
    v_add_u32 v46, -1, v46
    v_add_u32 v47, -1, v47
    v_ashrrev_i32 v44, 31, v44
    v_ashrrev_i32 v45, 31, v45
    v_ashrrev_i32 v46, 31, v46
    v_ashrrev_i32 v47, 31, v47
    v_and_b32 v36, v32, v44
    v_and_b32 v37, v33, v44
    v_and_b32 v38, v34, v44
    v_and_b32 v39, v35, v44
    v_and_b32_dpp v40, v32, v44 row_ror:12 row_mask:0xf bank_mask:0xf
    s_nop 0
    v_mfma_f32_16x16x32_bf16 v[64:67], a[0:3], v[36:39], 0
    v_and_b32_dpp v41, v33, v44 row_ror:12 row_mask:0xf bank_mask:0xf
    v_and_b32_dpp v42, v34, v44 row_ror:12 row_mask:0xf bank_mask:0xf
    v_mfma_f32_16x16x32_bf16 v[68:71], a[16:19], v[36:39], 0
    v_and_b32_dpp v43, v35, v44 row_ror:12 row_mask:0xf bank_mask:0xf
    v_mfma_f32_16x16x32_bf16 v[72:75], a[32:35], v[36:39], 0
    v_mfma_f32_16x16x32_bf16 v[76:79], a[48:51], v[36:39], 0
    v_and_b32_dpp v36, v32, v44 row_ror:8 row_mask:0xf bank_mask:0xf
    v_and_b32_dpp v37, v33, v44 row_ror:8 row_mask:0xf bank_mask:0xf
    v_mfma_f32_16x16x32_bf16 v[64:67], a[4:7], v[40:43], v[64:67]
    v_and_b32_dpp v38, v34, v44 row_ror:8 row_mask:0xf bank_mask:0xf
    v_and_b32_dpp v39, v35, v44 row_ror:8 row_mask:0xf bank_mask:0xf
    v_mfma_f32_16x16x32_bf16 v[68:71], a[20:23], v[40:43], v[68:71]
    v_mfma_f32_16x16x32_bf16 v[72:75], a[36:39], v[40:43], v[72:75]
    v_mfma_f32_16x16x32_bf16 v[76:79], a[52:55], v[40:43], v[76:79]
    v_and_b32_dpp v40, v32, v44 row_ror:4 row_mask:0xf bank_mask:0xf
    v_and_b32_dpp v41, v33, v44 row_ror:4 row_mask:0xf bank_mask:0xf
    v_mfma_f32_16x16x32_bf16 v[64:67], a[8:11], v[36:39], v[64:67]
    v_and_b32_dpp v42, v34, v44 row_ror:4 row_mask:0xf bank_mask:0xf
    v_and_b32_dpp v43, v35, v44 row_ror:4 row_mask:0xf bank_mask:0xf
    s_add_u32 m0, s25, 10240
    s_xor_b32 s97, s24, 1573120
    s_cmp_lg_u32 s98, 0
    s_cbranch_scc1 L_big104
    s_waitcnt vmcnt(6)
L_big104:
    s_waitcnt vmcnt(11)
    buffer_load_dwordx4 v56, s[12:15], s97 offen nt lds
    v_mfma_f32_16x16x32_bf16 v[68:71], a[24:27], v[36:39], v[68:71]
    v_mfma_f32_16x16x32_bf16 v[72:75], a[40:43], v[36:39], v[72:75]
    v_mfma_f32_16x16x32_bf16 v[76:79], a[56:59], v[36:39], v[76:79]
    v_and_b32_dpp v36, v32, v45 row_ror:4 row_mask:0xf bank_mask:0xf
    v_and_b32_dpp v37, v33, v45 row_ror:4 row_mask:0xf bank_mask:0xf
    v_mfma_f32_16x16x32_bf16 v[64:67], a[12:15], v[40:43], v[64:67]
    v_and_b32_dpp v38, v34, v45 row_ror:4 row_mask:0xf bank_mask:0xf
    v_and_b32_dpp v39, v35, v45 row_ror:4 row_mask:0xf bank_mask:0xf
    v_mfma_f32_16x16x32_bf16 v[68:71], a[28:31], v[40:43], v[68:71]
    v_mfma_f32_16x16x32_bf16 v[72:75], a[44:47], v[40:43], v[72:75]
    v_mfma_f32_16x16x32_bf16 v[76:79], a[60:63], v[40:43], v[76:79]
    v_and_b32 v40, v32, v45
    v_and_b32 v41, v33, v45
    v_mfma_f32_16x16x32_bf16 v[64:67], a[64:67], v[36:39], v[64:67]
    v_and_b32 v42, v34, v45
    v_and_b32 v43, v35, v45
    v_mfma_f32_16x16x32_bf16 v[68:71], a[80:83], v[36:39], v[68:71]
    v_mfma_f32_16x16x32_bf16 v[72:75], a[96:99], v[36:39], v[72:75]
    v_mfma_f32_16x16x32_bf16 v[76:79], a[112:115], v[36:39], v[76:79]
    v_and_b32_dpp v36, v32, v45 row_ror:12 row_mask:0xf bank_mask:0xf
    v_and_b32_dpp v37, v33, v45 row_ror:12 row_mask:0xf bank_mask:0xf
    v_mfma_f32_16x16x32_bf16 v[64:67], a[68:71], v[40:43], v[64:67]
    v_and_b32_dpp v38, v34, v45 row_ror:12 row_mask:0xf bank_mask:0xf
    v_and_b32_dpp v39, v35, v45 row_ror:12 row_mask:0xf bank_mask:0xf
    v_mfma_f32_16x16x32_bf16 v[68:71], a[84:87], v[40:43], v[68:71]
    v_mfma_f32_16x16x32_bf16 v[72:75], a[100:103], v[40:43], v[72:75]
    v_mfma_f32_16x16x32_bf16 v[76:79], a[116:119], v[40:43], v[76:79]
    v_and_b32_dpp v40, v32, v45 row_ror:8 row_mask:0xf bank_mask:0xf
    v_and_b32_dpp v41, v33, v45 row_ror:8 row_mask:0xf bank_mask:0xf
    v_mfma_f32_16x16x32_bf16 v[64:67], a[72:75], v[36:39], v[64:67]
    v_and_b32_dpp v42, v34, v45 row_ror:8 row_mask:0xf bank_mask:0xf
    v_and_b32_dpp v43, v35, v45 row_ror:8 row_mask:0xf bank_mask:0xf
    s_add_u32 m0, s25, 11264
    s_xor_b32 s97, s24, 1574144
    s_cmp_lg_u32 s98, 0
    s_cbranch_scc1 L_big105
    s_waitcnt vmcnt(6)
L_big105:
    s_waitcnt vmcnt(11)
    buffer_load_dwordx4 v57, s[12:15], s97 offen nt lds
    v_mfma_f32_16x16x32_bf16 v[68:71], a[88:91], v[36:39], v[68:71]
    v_mfma_f32_16x16x32_bf16 v[72:75], a[104:107], v[36:39], v[72:75]
    v_mfma_f32_16x16x32_bf16 v[76:79], a[120:123], v[36:39], v[76:79]
    v_and_b32_dpp v36, v32, v46 row_ror:8 row_mask:0xf bank_mask:0xf
    v_and_b32_dpp v37, v33, v46 row_ror:8 row_mask:0xf bank_mask:0xf
    v_mfma_f32_16x16x32_bf16 v[64:67], a[76:79], v[40:43], v[64:67]
    v_and_b32_dpp v38, v34, v46 row_ror:8 row_mask:0xf bank_mask:0xf
    v_and_b32_dpp v39, v35, v46 row_ror:8 row_mask:0xf bank_mask:0xf
    v_mfma_f32_16x16x32_bf16 v[68:71], a[92:95], v[40:43], v[68:71]
    v_mfma_f32_16x16x32_bf16 v[72:75], a[108:111], v[40:43], v[72:75]
    v_mfma_f32_16x16x32_bf16 v[76:79], a[124:127], v[40:43], v[76:79]
    v_and_b32_dpp v40, v32, v46 row_ror:4 row_mask:0xf bank_mask:0xf
    v_and_b32_dpp v41, v33, v46 row_ror:4 row_mask:0xf bank_mask:0xf
    v_mfma_f32_16x16x32_bf16 v[64:67], a[128:131], v[36:39], v[64:67]
    v_and_b32_dpp v42, v34, v46 row_ror:4 row_mask:0xf bank_mask:0xf
    v_and_b32_dpp v43, v35, v46 row_ror:4 row_mask:0xf bank_mask:0xf
    v_mfma_f32_16x16x32_bf16 v[68:71], a[144:147], v[36:39], v[68:71]
    v_mfma_f32_16x16x32_bf16 v[72:75], a[160:163], v[36:39], v[72:75]
    v_mfma_f32_16x16x32_bf16 v[76:79], a[176:179], v[36:39], v[76:79]
    v_and_b32 v36, v32, v46
    v_and_b32 v37, v33, v46
    v_mfma_f32_16x16x32_bf16 v[64:67], a[132:135], v[40:43], v[64:67]
    v_and_b32 v38, v34, v46
    v_and_b32 v39, v35, v46
    v_mfma_f32_16x16x32_bf16 v[68:71], a[148:151], v[40:43], v[68:71]
    v_mfma_f32_16x16x32_bf16 v[72:75], a[164:167], v[40:43], v[72:75]
    v_mfma_f32_16x16x32_bf16 v[76:79], a[180:183], v[40:43], v[76:79]
    v_and_b32_dpp v40, v32, v46 row_ror:12 row_mask:0xf bank_mask:0xf
    v_and_b32_dpp v41, v33, v46 row_ror:12 row_mask:0xf bank_mask:0xf
    v_mfma_f32_16x16x32_bf16 v[64:67], a[136:139], v[36:39], v[64:67]
    v_and_b32_dpp v42, v34, v46 row_ror:12 row_mask:0xf bank_mask:0xf
    v_and_b32_dpp v43, v35, v46 row_ror:12 row_mask:0xf bank_mask:0xf
    s_add_u32 m0, s25, 12288
    s_xor_b32 s97, s24, 1581056
    s_cmp_lg_u32 s98, 0
    s_cbranch_scc1 L_big106
    s_waitcnt vmcnt(6)
L_big106:
    s_waitcnt vmcnt(10)
    buffer_load_dwordx4 v56, s[12:15], s97 offen nt lds
    v_mfma_f32_16x16x32_bf16 v[68:71], a[152:155], v[36:39], v[68:71]
    v_mfma_f32_16x16x32_bf16 v[72:75], a[168:171], v[36:39], v[72:75]
    v_mfma_f32_16x16x32_bf16 v[76:79], a[184:187], v[36:39], v[76:79]
    v_and_b32_dpp v36, v32, v47 row_ror:12 row_mask:0xf bank_mask:0xf
    v_and_b32_dpp v37, v33, v47 row_ror:12 row_mask:0xf bank_mask:0xf
    v_mfma_f32_16x16x32_bf16 v[64:67], a[140:143], v[40:43], v[64:67]
    v_and_b32_dpp v38, v34, v47 row_ror:12 row_mask:0xf bank_mask:0xf
    v_and_b32_dpp v39, v35, v47 row_ror:12 row_mask:0xf bank_mask:0xf
    v_mfma_f32_16x16x32_bf16 v[68:71], a[156:159], v[40:43], v[68:71]
    v_mfma_f32_16x16x32_bf16 v[72:75], a[172:175], v[40:43], v[72:75]
    v_mfma_f32_16x16x32_bf16 v[76:79], a[188:191], v[40:43], v[76:79]
    v_and_b32_dpp v40, v32, v47 row_ror:8 row_mask:0xf bank_mask:0xf
    v_and_b32_dpp v41, v33, v47 row_ror:8 row_mask:0xf bank_mask:0xf
    v_mfma_f32_16x16x32_bf16 v[64:67], a[192:195], v[36:39], v[64:67]
    v_and_b32_dpp v42, v34, v47 row_ror:8 row_mask:0xf bank_mask:0xf
    v_and_b32_dpp v43, v35, v47 row_ror:8 row_mask:0xf bank_mask:0xf
    v_mfma_f32_16x16x32_bf16 v[68:71], a[208:211], v[36:39], v[68:71]
    v_mfma_f32_16x16x32_bf16 v[72:75], a[224:227], v[36:39], v[72:75]
    v_mfma_f32_16x16x32_bf16 v[76:79], a[240:243], v[36:39], v[76:79]
    v_and_b32_dpp v36, v32, v47 row_ror:4 row_mask:0xf bank_mask:0xf
    v_and_b32_dpp v37, v33, v47 row_ror:4 row_mask:0xf bank_mask:0xf
    v_mfma_f32_16x16x32_bf16 v[64:67], a[196:199], v[40:43], v[64:67]
    v_and_b32_dpp v38, v34, v47 row_ror:4 row_mask:0xf bank_mask:0xf
    v_and_b32_dpp v39, v35, v47 row_ror:4 row_mask:0xf bank_mask:0xf
    v_mfma_f32_16x16x32_bf16 v[68:71], a[212:215], v[40:43], v[68:71]
    v_mfma_f32_16x16x32_bf16 v[72:75], a[228:231], v[40:43], v[72:75]
    v_mfma_f32_16x16x32_bf16 v[76:79], a[244:247], v[40:43], v[76:79]
    v_and_b32 v40, v32, v47
    v_and_b32 v41, v33, v47
    v_mfma_f32_16x16x32_bf16 v[64:67], a[200:203], v[36:39], v[64:67]
    v_and_b32 v42, v34, v47
    v_and_b32 v43, v35, v47
    s_add_u32 m0, s25, 13312
    s_xor_b32 s97, s24, 1582080
    s_cmp_lg_u32 s98, 0
    s_cbranch_scc1 L_big107
    s_waitcnt vmcnt(6)
L_big107:
    s_waitcnt vmcnt(10)
    buffer_load_dwordx4 v57, s[12:15], s97 offen nt lds
    s_lshr_b32 s28, s3, 0
    s_lshr_b32 s29, s4, 0
    s_xor_b32 s28, s28, s29
    s_and_b32 s28, s28, 1
    s_xor_b32 s28, s28, 3
    s_lshl_b32 s29, s28, 10
    s_add_u32 m0, s100, s29
    s_and_b32 s28, s28, 1
    s_mul_i32 s28, s28, 229376
    s_add_u32 s30, s99, s28
    s_mov_b32 exec_lo, 0x0
    s_mov_b32 exec_hi, 0xffffffff
    buffer_load_dwordx4 v58, s[20:23], s30 offen lds
    s_mov_b64 exec, -1
    v_mfma_f32_16x16x32_bf16 v[68:71], a[216:219], v[36:39], v[68:71]
    v_mfma_f32_16x16x32_bf16 v[72:75], a[232:235], v[36:39], v[72:75]
    v_mfma_f32_16x16x32_bf16 v[76:79], a[248:251], v[36:39], v[76:79]
    v_mfma_f32_16x16x32_bf16 v[64:67], a[204:207], v[40:43], v[64:67]
    v_mfma_f32_16x16x32_bf16 v[68:71], a[220:223], v[40:43], v[68:71]
    v_mfma_f32_16x16x32_bf16 v[72:75], a[236:239], v[40:43], v[72:75]
    v_mfma_f32_16x16x32_bf16 v[76:79], a[252:255], v[40:43], v[76:79]
    v_mov_b32 v32, 0
    v_mov_b32 v33, 0
    v_mov_b32 v34, 0
    v_mov_b32 v35, 0
    v_mov_b32 v36, 0
    v_max3_f32 v14, v64, v65, v66
    v_max3_f32 v13, v67, v68, v69
    v_max3_f32 v14, v14, v70, v71
    v_max3_f32 v13, v13, v72, v73
    v_max3_f32 v14, v14, v74, v75
    v_max3_f32 v13, v13, v76, v77
    v_max3_f32 v14, v14, v78, v79
    v_max_f32 v14, v14, v13
    v_mov_b32 v37, 0
    v_mov_b32 v38, 0
    v_max_f32_dpp v14, v14, v14 row_ror:4 row_mask:0xf bank_mask:0xf
    v_mov_b32 v39, 0
    s_nop 0
    v_max_f32_dpp v14, v14, v14 row_ror:8 row_mask:0xf bank_mask:0xf
    v_mov_b32 v13, v14
    s_nop 1
    v_permlane16_swap_b32 v13, v14
    v_max_f32 v14, v13, v14
    v_mov_b32 v13, v14
    s_nop 1
    v_permlane32_swap_b32 v13, v14
    v_max_f32 v14, v13, v14
    v_mul_f32 v14, v14, v12
    v_pk_fma_f32 v[64:65], v[64:65], v[12:13], v[14:15] op_sel_hi:[1,0,0] neg_lo:[0,0,1] neg_hi:[0,0,1]
    v_pk_fma_f32 v[66:67], v[66:67], v[12:13], v[14:15] op_sel_hi:[1,0,0] neg_lo:[0,0,1] neg_hi:[0,0,1]
    v_pk_fma_f32 v[68:69], v[68:69], v[12:13], v[14:15] op_sel_hi:[1,0,0] neg_lo:[0,0,1] neg_hi:[0,0,1]
    v_pk_fma_f32 v[70:71], v[70:71], v[12:13], v[14:15] op_sel_hi:[1,0,0] neg_lo:[0,0,1] neg_hi:[0,0,1]
    v_pk_fma_f32 v[72:73], v[72:73], v[12:13], v[14:15] op_sel_hi:[1,0,0] neg_lo:[0,0,1] neg_hi:[0,0,1]
    v_pk_fma_f32 v[74:75], v[74:75], v[12:13], v[14:15] op_sel_hi:[1,0,0] neg_lo:[0,0,1] neg_hi:[0,0,1]
    v_pk_fma_f32 v[76:77], v[76:77], v[12:13], v[14:15] op_sel_hi:[1,0,0] neg_lo:[0,0,1] neg_hi:[0,0,1]
    v_pk_fma_f32 v[78:79], v[78:79], v[12:13], v[14:15] op_sel_hi:[1,0,0] neg_lo:[0,0,1] neg_hi:[0,0,1]
    s_add_u32 m0, s25, 14336
    s_xor_b32 s97, s24, 1581312
    s_cmp_lg_u32 s98, 0
    s_cbranch_scc1 L_big108
    s_waitcnt vmcnt(6)
L_big108:
    s_waitcnt vmcnt(11)
    buffer_load_dwordx4 v56, s[12:15], s97 offen nt lds
    v_exp_f32 v64, v64
    v_exp_f32 v65, v65
    v_exp_f32 v66, v66
    v_exp_f32 v67, v67
    v_exp_f32 v68, v68
    v_exp_f32 v69, v69
    v_exp_f32 v70, v70
    v_exp_f32 v71, v71
    v_exp_f32 v72, v72
    v_exp_f32 v73, v73
    v_exp_f32 v74, v74
    v_exp_f32 v75, v75
    v_exp_f32 v76, v76
    v_exp_f32 v77, v77
    v_exp_f32 v78, v78
    v_exp_f32 v79, v79
    v_cvt_pk_bf16_f32 v24, v64, v68
    v_cvt_pk_bf16_f32 v25, v65, v69
    v_cvt_pk_bf16_f32 v26, v72, v76
    v_cvt_pk_bf16_f32 v27, v73, v77
    v_cvt_pk_bf16_f32 v28, v66, v70
    v_cvt_pk_bf16_f32 v29, v67, v71
    v_cvt_pk_bf16_f32 v30, v74, v78
    v_cvt_pk_bf16_f32 v31, v75, v79
    s_add_u32 m0, s25, 15360
    s_xor_b32 s97, s24, 1582336
    s_cmp_lg_u32 s98, 0
    s_cbranch_scc1 L_big109
    s_waitcnt vmcnt(6)
L_big109:
    s_waitcnt vmcnt(11)
    buffer_load_dwordx4 v57, s[12:15], s97 offen nt lds
    v_add_f32 v15, v64, v65
    v_add_f32 v15, v15, v66
    v_add_f32 v15, v15, v67
    v_add_f32 v15, v15, v68
    v_add_f32 v15, v15, v69
    v_add_f32 v15, v15, v70
    v_add_f32 v15, v15, v71
    v_add_f32 v15, v15, v72
    v_add_f32 v15, v15, v73
    v_add_f32 v15, v15, v74
    v_add_f32 v15, v15, v75
    v_add_f32 v15, v15, v76
    v_add_f32 v15, v15, v77
    v_add_f32 v15, v15, v78
    v_add_f32 v15, v15, v79
    s_nop 1
    v_add_f32_dpp v15, v15, v15 row_ror:4 row_mask:0xf bank_mask:0xf
    s_nop 1
    v_add_f32_dpp v15, v15, v15 row_ror:8 row_mask:0xf bank_mask:0xf
    v_mov_b32 v13, v15
    s_nop 1
    v_permlane16_swap_b32 v13, v15
    v_add_f32 v15, v13, v15
    v_mov_b32 v13, v15
    s_nop 1
    v_permlane32_swap_b32 v13, v15
    v_add_f32 v15, v13, v15
    ds_write_b64 v19, v[14:15]
    s_lshl_b32 s28, s3, 5
    s_add_u32 s28, s28, 156160
    v_mov_b32 v12, s28
    s_cmp_lg_u32 s3, 3
    s_cbranch_scc1 L_nopre
    s_lshl_b32 s28, s4, 15
    s_lshl_b32 s29, s5, 10
    s_add_u32 s28, s28, s29
    v_lshl_add_u32 v58, v1, 3, s28
    s_lshl_b32 s28, s4, 12
    s_lshl_b32 s29, s5, 7
    s_add_u32 s28, s28, s29
    s_add_u32 s28, s28, 360448
    v_writelane_b32 v58, s28, 8
    s_lshr_b32 s28, s5, 4
    s_mul_i32 s28, s28, 16384
    s_and_b32 s30, s29, 0x780
    s_add_u32 s28, s28, s30
    s_add_u32 s28, s28, s72
    v_writelane_b32 v58, s28, 9
    s_lshr_b32 s28, s5, 4
    s_mul_i32 s28, s28, 8192
    s_and_b32 s30, s29, 0x380
    s_add_u32 s28, s28, s30
    s_lshl_b32 s30, s4, 10
    s_add_u32 s28, s28, s30
    s_add_u32 s28, s28, 425984
    v_writelane_b32 v58, s28, 10
    s_mov_b32 s20, s54
    s_and_b32 s21, s55, 0xffff
    s_mov_b32 s22, 4096
    s_mov_b32 s23, 0x20000
    s_mov_b32 m0, 158272
    s_mov_b64 exec, 0x7ff
    buffer_load_dword v58, s[16:19], 0 offen sc1 lds
    s_mov_b64 exec, 1
    s_lshl_b32 s28, s4, 7
    buffer_load_dword v1, s[20:23], s28 offen lds
    s_mov_b64 exec, -1
L_nopre:
    s_add_u32 m0, s25, 16384
    s_xor_b32 s97, s24, 528384
    buffer_load_dwordx4 v56, s[12:15], s97 offen nt lds
    s_waitcnt lgkmcnt(0)
    v_mov_b32_dpp v32, v24 quad_perm:[0,1,2,3] row_mask:0xf bank_mask:0x1
    v_mov_b32_dpp v33, v25 quad_perm:[0,1,2,3] row_mask:0xf bank_mask:0x1
    v_mov_b32_dpp v34, v26 quad_perm:[0,1,2,3] row_mask:0xf bank_mask:0x1
    v_mov_b32_dpp v35, v27 quad_perm:[0,1,2,3] row_mask:0xf bank_mask:0x1
    v_mov_b32_dpp v36, v24 row_ror:4 row_mask:0xf bank_mask:0x2
    v_mov_b32_dpp v37, v25 row_ror:4 row_mask:0xf bank_mask:0x2
    v_mov_b32_dpp v38, v26 row_ror:4 row_mask:0xf bank_mask:0x2
    v_mov_b32_dpp v39, v27 row_ror:4 row_mask:0xf bank_mask:0x2
    v_mfma_f32_16x16x32_bf16 v[40:43], v[128:131], v[32:35], 0
    v_mfma_f32_16x16x32_bf16 v[44:47], v[144:147], v[32:35], 0
    v_mfma_f32_16x16x32_bf16 v[48:51], v[160:163], v[32:35], 0
    v_mfma_f32_16x16x32_bf16 v[52:55], v[176:179], v[32:35], 0
    v_mfma_f32_16x16x32_bf16 v[40:43], v[136:139], v[36:39], v[40:43]
    v_mfma_f32_16x16x32_bf16 v[44:47], v[152:155], v[36:39], v[44:47]
    v_mfma_f32_16x16x32_bf16 v[48:51], v[168:171], v[36:39], v[48:51]
    v_mfma_f32_16x16x32_bf16 v[52:55], v[184:187], v[36:39], v[52:55]
    s_add_u32 m0, s25, 17408
    s_xor_b32 s97, s24, 529408
    buffer_load_dwordx4 v57, s[12:15], s97 offen nt lds
    s_waitcnt lgkmcnt(0)
    v_mov_b32_dpp v32, v28 quad_perm:[0,1,2,3] row_mask:0xf bank_mask:0x1
    v_mov_b32_dpp v33, v29 quad_perm:[0,1,2,3] row_mask:0xf bank_mask:0x1
    v_mov_b32_dpp v34, v30 quad_perm:[0,1,2,3] row_mask:0xf bank_mask:0x1
    v_mov_b32_dpp v35, v31 quad_perm:[0,1,2,3] row_mask:0xf bank_mask:0x1
    v_mov_b32_dpp v36, v28 row_ror:4 row_mask:0xf bank_mask:0x2
    v_mov_b32_dpp v37, v29 row_ror:4 row_mask:0xf bank_mask:0x2
    v_mov_b32_dpp v38, v30 row_ror:4 row_mask:0xf bank_mask:0x2
    v_mov_b32_dpp v39, v31 row_ror:4 row_mask:0xf bank_mask:0x2
    v_mfma_f32_16x16x32_bf16 v[40:43], v[132:135], v[32:35], v[40:43]
    v_mfma_f32_16x16x32_bf16 v[44:47], v[148:151], v[32:35], v[44:47]
    v_mfma_f32_16x16x32_bf16 v[48:51], v[164:167], v[32:35], v[48:51]
    v_mfma_f32_16x16x32_bf16 v[52:55], v[180:183], v[32:35], v[52:55]
    v_mfma_f32_16x16x32_bf16 v[40:43], v[140:143], v[36:39], v[40:43]
    v_mfma_f32_16x16x32_bf16 v[44:47], v[156:159], v[36:39], v[44:47]
    v_mfma_f32_16x16x32_bf16 v[48:51], v[172:175], v[36:39], v[48:51]
    v_mfma_f32_16x16x32_bf16 v[52:55], v[188:191], v[36:39], v[52:55]
    s_add_u32 m0, s25, 18432
    s_xor_b32 s97, s24, 528640
    s_waitcnt vmcnt(13)
    buffer_load_dwordx4 v56, s[12:15], s97 offen nt lds
    s_waitcnt lgkmcnt(0)
    v_mov_b32_dpp v32, v24 row_ror:12 row_mask:0xf bank_mask:0x1
    v_mov_b32_dpp v33, v25 row_ror:12 row_mask:0xf bank_mask:0x1
    v_mov_b32_dpp v34, v26 row_ror:12 row_mask:0xf bank_mask:0x1
    v_mov_b32_dpp v35, v27 row_ror:12 row_mask:0xf bank_mask:0x1
    v_mov_b32_dpp v36, v24 quad_perm:[0,1,2,3] row_mask:0xf bank_mask:0x2
    v_mov_b32_dpp v37, v25 quad_perm:[0,1,2,3] row_mask:0xf bank_mask:0x2
    v_mov_b32_dpp v38, v26 quad_perm:[0,1,2,3] row_mask:0xf bank_mask:0x2
    v_mov_b32_dpp v39, v27 quad_perm:[0,1,2,3] row_mask:0xf bank_mask:0x2
    v_mfma_f32_16x16x32_bf16 v[40:43], v[192:195], v[32:35], v[40:43]
    v_mfma_f32_16x16x32_bf16 v[44:47], v[208:211], v[32:35], v[44:47]
    v_mfma_f32_16x16x32_bf16 v[48:51], v[224:227], v[32:35], v[48:51]
    v_mfma_f32_16x16x32_bf16 v[52:55], v[240:243], v[32:35], v[52:55]
    v_mfma_f32_16x16x32_bf16 v[40:43], v[200:203], v[36:39], v[40:43]
    v_mfma_f32_16x16x32_bf16 v[44:47], v[216:219], v[36:39], v[44:47]
    v_mfma_f32_16x16x32_bf16 v[48:51], v[232:235], v[36:39], v[48:51]
    v_mfma_f32_16x16x32_bf16 v[52:55], v[248:251], v[36:39], v[52:55]
    s_add_u32 m0, s25, 19456
    s_xor_b32 s97, s24, 529664
    s_waitcnt vmcnt(13)
    buffer_load_dwordx4 v57, s[12:15], s97 offen nt lds
    s_waitcnt lgkmcnt(0)
    v_mov_b32_dpp v32, v28 row_ror:12 row_mask:0xf bank_mask:0x1
    v_mov_b32_dpp v33, v29 row_ror:12 row_mask:0xf bank_mask:0x1
    v_mov_b32_dpp v34, v30 row_ror:12 row_mask:0xf bank_mask:0x1
    v_mov_b32_dpp v35, v31 row_ror:12 row_mask:0xf bank_mask:0x1
    v_mov_b32_dpp v36, v28 quad_perm:[0,1,2,3] row_mask:0xf bank_mask:0x2
    v_mov_b32_dpp v37, v29 quad_perm:[0,1,2,3] row_mask:0xf bank_mask:0x2
    v_mov_b32_dpp v38, v30 quad_perm:[0,1,2,3] row_mask:0xf bank_mask:0x2
    v_mov_b32_dpp v39, v31 quad_perm:[0,1,2,3] row_mask:0xf bank_mask:0x2
    v_mfma_f32_16x16x32_bf16 v[40:43], v[196:199], v[32:35], v[40:43]
    v_mfma_f32_16x16x32_bf16 v[44:47], v[212:215], v[32:35], v[44:47]
    v_mfma_f32_16x16x32_bf16 v[48:51], v[228:231], v[32:35], v[48:51]
    v_mfma_f32_16x16x32_bf16 v[52:55], v[244:247], v[32:35], v[52:55]
    v_mfma_f32_16x16x32_bf16 v[40:43], v[204:207], v[36:39], v[40:43]
    v_mfma_f32_16x16x32_bf16 v[44:47], v[220:223], v[36:39], v[44:47]
    v_mfma_f32_16x16x32_bf16 v[48:51], v[236:239], v[36:39], v[48:51]
    v_mfma_f32_16x16x32_bf16 v[52:55], v[252:255], v[36:39], v[52:55]
    s_cmp_gt_u32 s3, 0
    s_cbranch_scc1 L_noprio
    s_setprio 3
L_noprio:
    ds_read_b64_tr_b16 v[64:65], v2 offset:0
    ds_read_b64_tr_b16 v[66:67], v2 offset:4096
    ds_read_b64_tr_b16 v[68:69], v4 offset:0
    ds_read_b64_tr_b16 v[70:71], v4 offset:4096
    ds_read_b64_tr_b16 v[72:73], v6 offset:0
    ds_read_b64_tr_b16 v[74:75], v6 offset:4096
    ds_read_b64_tr_b16 v[76:77], v8 offset:0
    ds_read_b64_tr_b16 v[78:79], v8 offset:4096
    v_mov_b32_dpp v32, v24 row_ror:8 row_mask:0xf bank_mask:0x1
    v_mov_b32_dpp v33, v25 row_ror:8 row_mask:0xf bank_mask:0x1
    v_mov_b32_dpp v34, v26 row_ror:8 row_mask:0xf bank_mask:0x1
    v_mov_b32_dpp v35, v27 row_ror:8 row_mask:0xf bank_mask:0x1
    v_mov_b32_dpp v36, v24 row_ror:12 row_mask:0xf bank_mask:0x2
    v_mov_b32_dpp v37, v25 row_ror:12 row_mask:0xf bank_mask:0x2
    v_mov_b32_dpp v38, v26 row_ror:12 row_mask:0xf bank_mask:0x2
    v_mov_b32_dpp v39, v27 row_ror:12 row_mask:0xf bank_mask:0x2
    ds_read_b64_tr_b16 v[60:61], v3 offset:0
    ds_read_b64_tr_b16 v[62:63], v3 offset:4096
    s_waitcnt lgkmcnt(8)
    v_mfma_f32_16x16x32_bf16 v[40:43], v[64:67], v[32:35], v[40:43]
    ds_read_b64_tr_b16 v[64:65], v5 offset:0
    ds_read_b64_tr_b16 v[66:67], v5 offset:4096
    s_waitcnt lgkmcnt(8)
    v_mfma_f32_16x16x32_bf16 v[44:47], v[68:71], v[32:35], v[44:47]
    ds_read_b64_tr_b16 v[68:69], v7 offset:0
    ds_read_b64_tr_b16 v[70:71], v7 offset:4096
    s_waitcnt lgkmcnt(8)
    v_mfma_f32_16x16x32_bf16 v[48:51], v[72:75], v[32:35], v[48:51]
    ds_read_b64_tr_b16 v[72:73], v9 offset:0
    ds_read_b64_tr_b16 v[74:75], v9 offset:4096
    s_waitcnt lgkmcnt(8)
    v_mfma_f32_16x16x32_bf16 v[52:55], v[76:79], v[32:35], v[52:55]
    s_waitcnt lgkmcnt(6)
    v_mfma_f32_16x16x32_bf16 v[40:43], v[60:63], v[36:39], v[40:43]
    s_waitcnt lgkmcnt(4)
    v_mfma_f32_16x16x32_bf16 v[44:47], v[64:67], v[36:39], v[44:47]
    s_waitcnt lgkmcnt(2)
    v_mfma_f32_16x16x32_bf16 v[48:51], v[68:71], v[36:39], v[48:51]
    s_waitcnt lgkmcnt(0)
    v_mfma_f32_16x16x32_bf16 v[52:55], v[72:75], v[36:39], v[52:55]
    s_add_u32 m0, s25, 20480
    s_xor_b32 s97, s24, 536576
    s_waitcnt vmcnt(12)
    buffer_load_dwordx4 v56, s[12:15], s97 offen nt lds
    s_add_u32 m0, s25, 21504
    s_xor_b32 s97, s24, 537600
    s_waitcnt vmcnt(12)
    buffer_load_dwordx4 v57, s[12:15], s97 offen nt lds
    s_add_u32 m0, s25, 22528
    s_xor_b32 s97, s24, 536832
    s_waitcnt vmcnt(12)
    buffer_load_dwordx4 v56, s[12:15], s97 offen nt lds
    s_add_u32 m0, s25, 23552
    s_xor_b32 s97, s24, 537856
    s_waitcnt vmcnt(12)
    buffer_load_dwordx4 v57, s[12:15], s97 offen nt lds
    s_add_u32 m0, s25, 24576
    s_xor_b32 s97, s24, 1576960
    s_waitcnt vmcnt(12)
    buffer_load_dwordx4 v56, s[12:15], s97 offen nt lds
    s_add_u32 m0, s25, 25600
    s_xor_b32 s97, s24, 1577984
    s_waitcnt vmcnt(12)
    buffer_load_dwordx4 v57, s[12:15], s97 offen nt lds
    s_add_u32 m0, s25, 26624
    s_xor_b32 s97, s24, 1577216
    s_waitcnt vmcnt(11)
    buffer_load_dwordx4 v56, s[12:15], s97 offen nt lds
    s_add_u32 m0, s25, 27648
    s_xor_b32 s97, s24, 1578240
    s_waitcnt vmcnt(11)
    buffer_load_dwordx4 v57, s[12:15], s97 offen nt lds
    ds_read_b64_tr_b16 v[64:65], v2 offset:8192
    ds_read_b64_tr_b16 v[66:67], v2 offset:12288
    ds_read_b64_tr_b16 v[68:69], v4 offset:8192
    ds_read_b64_tr_b16 v[70:71], v4 offset:12288
    ds_read_b64_tr_b16 v[72:73], v6 offset:8192
    ds_read_b64_tr_b16 v[74:75], v6 offset:12288
    ds_read_b64_tr_b16 v[76:77], v8 offset:8192
    ds_read_b64_tr_b16 v[78:79], v8 offset:12288
    v_mov_b32_dpp v32, v28 row_ror:8 row_mask:0xf bank_mask:0x1
    v_mov_b32_dpp v33, v29 row_ror:8 row_mask:0xf bank_mask:0x1
    v_mov_b32_dpp v34, v30 row_ror:8 row_mask:0xf bank_mask:0x1
    v_mov_b32_dpp v35, v31 row_ror:8 row_mask:0xf bank_mask:0x1
    v_mov_b32_dpp v36, v28 row_ror:12 row_mask:0xf bank_mask:0x2
    v_mov_b32_dpp v37, v29 row_ror:12 row_mask:0xf bank_mask:0x2
    v_mov_b32_dpp v38, v30 row_ror:12 row_mask:0xf bank_mask:0x2
    v_mov_b32_dpp v39, v31 row_ror:12 row_mask:0xf bank_mask:0x2
    ds_read_b64_tr_b16 v[60:61], v3 offset:8192
    ds_read_b64_tr_b16 v[62:63], v3 offset:12288
    s_waitcnt lgkmcnt(8)
    v_mfma_f32_16x16x32_bf16 v[40:43], v[64:67], v[32:35], v[40:43]
    ds_read_b64_tr_b16 v[64:65], v5 offset:8192
    ds_read_b64_tr_b16 v[66:67], v5 offset:12288
    s_waitcnt lgkmcnt(8)
    v_mfma_f32_16x16x32_bf16 v[44:47], v[68:71], v[32:35], v[44:47]
    ds_read_b64_tr_b16 v[68:69], v7 offset:8192
    ds_read_b64_tr_b16 v[70:71], v7 offset:12288
    s_waitcnt lgkmcnt(8)
    v_mfma_f32_16x16x32_bf16 v[48:51], v[72:75], v[32:35], v[48:51]
    ds_read_b64_tr_b16 v[72:73], v9 offset:8192
    ds_read_b64_tr_b16 v[74:75], v9 offset:12288
    s_waitcnt lgkmcnt(8)
    v_mfma_f32_16x16x32_bf16 v[52:55], v[76:79], v[32:35], v[52:55]
    s_waitcnt lgkmcnt(6)
    v_mfma_f32_16x16x32_bf16 v[40:43], v[60:63], v[36:39], v[40:43]
    s_waitcnt lgkmcnt(4)
    v_mfma_f32_16x16x32_bf16 v[44:47], v[64:67], v[36:39], v[44:47]
    s_waitcnt lgkmcnt(2)
    v_mfma_f32_16x16x32_bf16 v[48:51], v[68:71], v[36:39], v[48:51]
    s_waitcnt lgkmcnt(0)
    v_mfma_f32_16x16x32_bf16 v[52:55], v[72:75], v[36:39], v[52:55]
    s_add_u32 m0, s25, 28672
    s_xor_b32 s97, s24, 1585152
    s_waitcnt vmcnt(11)
    buffer_load_dwordx4 v56, s[12:15], s97 offen nt lds
    s_add_u32 m0, s25, 29696
    s_xor_b32 s97, s24, 1586176
    s_waitcnt vmcnt(11)
    buffer_load_dwordx4 v57, s[12:15], s97 offen nt lds
    s_add_u32 m0, s25, 30720
    s_xor_b32 s97, s24, 1585408
    s_waitcnt vmcnt(11)
    buffer_load_dwordx4 v56, s[12:15], s97 offen nt lds
    s_add_u32 m0, s25, 31744
    s_xor_b32 s97, s24, 1586432
    s_waitcnt vmcnt(11)
    buffer_load_dwordx4 v57, s[12:15], s97 offen nt lds
    s_waitcnt vmcnt(18)
    v_lshrrev_b32 v58, 8, v1
    v_lshlrev_b32 v58, 7, v58
    v_and_b32 v59, 0xc0, v1
    v_lshrrev_b32 v59, 2, v59
    v_add_u32 v58, v58, v59
    v_and_b32 v59, 0x20, v1
    v_lshl_add_u32 v58, v59, 6, v58
    v_and_b32 v59, 0x10, v1
    v_lshrrev_b32 v59, 1, v59
    v_add3_u32 v58, v58, v59, s83
    ds_read_b64_tr_b16 v[112:113], v58 offset:0
    ds_read_b64_tr_b16 v[114:115], v58 offset:64
    ds_read_b64_tr_b16 v[116:117], v58 offset:512
    ds_read_b64_tr_b16 v[118:119], v58 offset:576
    ds_read_b64_tr_b16 v[120:121], v58 offset:1024
    ds_read_b64_tr_b16 v[122:123], v58 offset:1088
    ds_read_b64_tr_b16 v[124:125], v58 offset:1536
    ds_read_b64_tr_b16 v[126:127], v58 offset:1600
    s_waitcnt lgkmcnt(0)
    v_mfma_f32_16x16x32_bf16 v[72:75], v[20:23], v[112:115], 0
    v_mfma_f32_16x16x32_bf16 v[72:75], v[20:23], v[116:119], v[72:75]
    v_mfma_f32_16x16x32_bf16 v[72:75], v[20:23], v[120:123], v[72:75]
    v_mfma_f32_16x16x32_bf16 v[72:75], v[20:23], v[124:127], v[72:75]
    s_lshl_b32 s28, s3, 2
    s_add_u32 s28, s28, 157952
    v_and_b32 v58, 0xf0, v1
    v_add_u32 v58, s28, v58
    s_nop 3
    ds_write_b32 v58, v72
    v_mov_b32 v58, 0xffbfffbf
    buffer_store_dword v58, v18, s[16:19], s93 offen
    buffer_store_dword v58, v18, s[16:19], s94 offen sc1
    v_mov_b32 v60, 0xffbfffbf
    v_mov_b32 v61, 0xffbfffbf
    v_mov_b32 v62, 0xffbfffbf
    v_mov_b32 v63, 0xffbfffbf
L_pad3:
    s_cbranch_execz L_ret
    s_mul_i32 s28, s2, 768
    s_lshl_b32 s29, s3, 8
    s_add_u32 s28, s28, s29
    s_add_u32 s28, s28, 458496
    s_cmp_eq_u32 s3, 0
    s_cselect_b32 s28, 4194304, s28
    s_mov_b64 exec, 0xffff
    buffer_store_dwordx4 v[60:63], v1, s[16:19], s28 offen sc1
    s_mov_b64 exec, -1
    s_waitcnt lgkmcnt(0)
    s_barrier
    ds_read_b128 v[64:67], v12
    ds_read_b128 v[68:71], v12 offset:16
    s_waitcnt lgkmcnt(0)
    v_max3_f32 v14, v64, v66, v68
    v_max_f32 v14, v14, v70
    v_sub_f32 v20, v64, v14
    v_sub_f32 v21, v66, v14
    v_sub_f32 v22, v68, v14
    v_sub_f32 v23, v70, v14
    v_exp_f32 v20, v20
    v_exp_f32 v21, v21
    v_exp_f32 v22, v22
    v_exp_f32 v23, v23
    v_mul_f32 v15, v20, v65
    v_fmac_f32 v15, v21, v67
    v_fmac_f32 v15, v22, v69
    v_fmac_f32 v15, v23, v71
    s_waitcnt vmcnt(11)
    ds_read_b64_tr_b16 v[64:65], v2 offset:16384
    ds_read_b64_tr_b16 v[66:67], v2 offset:20480
    ds_read_b64_tr_b16 v[68:69], v4 offset:16384
    ds_read_b64_tr_b16 v[70:71], v4 offset:20480
    ds_read_b64_tr_b16 v[72:73], v6 offset:16384
    ds_read_b64_tr_b16 v[74:75], v6 offset:20480
    ds_read_b64_tr_b16 v[76:77], v8 offset:16384
    ds_read_b64_tr_b16 v[78:79], v8 offset:20480
    v_mov_b32_dpp v32, v24 row_ror:4 row_mask:0xf bank_mask:0x1
    v_mov_b32_dpp v33, v25 row_ror:4 row_mask:0xf bank_mask:0x1
    v_mov_b32_dpp v34, v26 row_ror:4 row_mask:0xf bank_mask:0x1
    v_mov_b32_dpp v35, v27 row_ror:4 row_mask:0xf bank_mask:0x1
    v_mov_b32_dpp v36, v24 row_ror:8 row_mask:0xf bank_mask:0x2
    v_mov_b32_dpp v37, v25 row_ror:8 row_mask:0xf bank_mask:0x2
    v_mov_b32_dpp v38, v26 row_ror:8 row_mask:0xf bank_mask:0x2
    v_mov_b32_dpp v39, v27 row_ror:8 row_mask:0xf bank_mask:0x2
    ds_read_b64_tr_b16 v[60:61], v3 offset:16384
    ds_read_b64_tr_b16 v[62:63], v3 offset:20480
    s_waitcnt lgkmcnt(8)
    v_mfma_f32_16x16x32_bf16 v[40:43], v[64:67], v[32:35], v[40:43]
    ds_read_b64_tr_b16 v[64:65], v5 offset:16384
    ds_read_b64_tr_b16 v[66:67], v5 offset:20480
    s_waitcnt lgkmcnt(8)
    v_mfma_f32_16x16x32_bf16 v[44:47], v[68:71], v[32:35], v[44:47]
    ds_read_b64_tr_b16 v[68:69], v7 offset:16384
    ds_read_b64_tr_b16 v[70:71], v7 offset:20480
    s_waitcnt lgkmcnt(8)
    v_mfma_f32_16x16x32_bf16 v[48:51], v[72:75], v[32:35], v[48:51]
    ds_read_b64_tr_b16 v[72:73], v9 offset:16384
    ds_read_b64_tr_b16 v[74:75], v9 offset:20480
    s_waitcnt lgkmcnt(8)
    v_mfma_f32_16x16x32_bf16 v[52:55], v[76:79], v[32:35], v[52:55]
    s_waitcnt lgkmcnt(6)
    v_mfma_f32_16x16x32_bf16 v[40:43], v[60:63], v[36:39], v[40:43]
    s_waitcnt lgkmcnt(4)
    v_mfma_f32_16x16x32_bf16 v[44:47], v[64:67], v[36:39], v[44:47]
    s_waitcnt lgkmcnt(2)
    v_mfma_f32_16x16x32_bf16 v[48:51], v[68:71], v[36:39], v[48:51]
    s_waitcnt lgkmcnt(0)
    v_mfma_f32_16x16x32_bf16 v[52:55], v[72:75], v[36:39], v[52:55]
    v_mov_b32_dpp v32, v28 row_ror:4 row_mask:0xf bank_mask:0x1
    v_mov_b32_dpp v33, v29 row_ror:4 row_mask:0xf bank_mask:0x1
    v_mov_b32_dpp v34, v30 row_ror:4 row_mask:0xf bank_mask:0x1
    v_mov_b32_dpp v35, v31 row_ror:4 row_mask:0xf bank_mask:0x1
    v_mov_b32_dpp v36, v28 row_ror:8 row_mask:0xf bank_mask:0x2
    v_mov_b32_dpp v37, v29 row_ror:8 row_mask:0xf bank_mask:0x2
    v_mov_b32_dpp v38, v30 row_ror:8 row_mask:0xf bank_mask:0x2
    v_mov_b32_dpp v39, v31 row_ror:8 row_mask:0xf bank_mask:0x2
    s_waitcnt vmcnt(7)
    ds_read_b64_tr_b16 v[64:65], v4 offset:24576
    ds_read_b64_tr_b16 v[68:69], v2 offset:24576
    ds_read_b64_tr_b16 v[72:73], v5 offset:24576
    ds_read_b64_tr_b16 v[76:77], v3 offset:24576
    ds_read_b64_tr_b16 v[60:61], v8 offset:24576
    ds_read_b64_tr_b16 v[56:57], v6 offset:24576
    ds_read_b64_tr_b16 v[24:25], v9 offset:24576
    ds_read_b64_tr_b16 v[28:29], v7 offset:24576
    s_waitcnt vmcnt(3)
    ds_read_b64_tr_b16 v[66:67], v4 offset:28672
    ds_read_b64_tr_b16 v[70:71], v2 offset:28672
    ds_read_b64_tr_b16 v[74:75], v5 offset:28672
    ds_read_b64_tr_b16 v[78:79], v3 offset:28672
    ds_read_b64_tr_b16 v[62:63], v8 offset:28672
    ds_read_b64_tr_b16 v[58:59], v6 offset:28672
    ds_read_b64_tr_b16 v[26:27], v9 offset:28672
    ds_read_b64_tr_b16 v[30:31], v7 offset:28672
    s_waitcnt lgkmcnt(7)
    v_mfma_f32_16x16x32_bf16 v[44:47], v[64:67], v[32:35], v[44:47]
    s_waitcnt lgkmcnt(6)
    v_mfma_f32_16x16x32_bf16 v[40:43], v[68:71], v[32:35], v[40:43]
    s_waitcnt lgkmcnt(5)
    v_mfma_f32_16x16x32_bf16 v[44:47], v[72:75], v[36:39], v[44:47]
    s_waitcnt lgkmcnt(4)
    v_mfma_f32_16x16x32_bf16 v[40:43], v[76:79], v[36:39], v[40:43]
    s_waitcnt lgkmcnt(3)
    v_mfma_f32_16x16x32_bf16 v[52:55], v[60:63], v[32:35], v[52:55]
    s_waitcnt lgkmcnt(2)
    v_mfma_f32_16x16x32_bf16 v[48:51], v[56:59], v[32:35], v[48:51]
    s_waitcnt lgkmcnt(1)
    v_mfma_f32_16x16x32_bf16 v[52:55], v[24:27], v[36:39], v[52:55]
    s_waitcnt lgkmcnt(0)
    v_mfma_f32_16x16x32_bf16 v[48:51], v[28:31], v[36:39], v[48:51]
L_comb:
    v_mov_b32_dpp v40, v44 row_ror:8 row_mask:0xf bank_mask:0xc
    v_mov_b32_dpp v41, v45 row_ror:8 row_mask:0xf bank_mask:0xc
    v_mov_b32_dpp v42, v46 row_ror:8 row_mask:0xf bank_mask:0xc
    v_mov_b32_dpp v43, v47 row_ror:8 row_mask:0xf bank_mask:0xc
    ds_write_b128 v16, v[40:43] offset:0
    s_nop 2
    v_mov_b32_dpp v48, v52 row_ror:8 row_mask:0xf bank_mask:0xc
    v_mov_b32_dpp v49, v53 row_ror:8 row_mask:0xf bank_mask:0xc
    v_mov_b32_dpp v50, v54 row_ror:8 row_mask:0xf bank_mask:0xc
    v_mov_b32_dpp v51, v55 row_ror:8 row_mask:0xf bank_mask:0xc
    ds_write_b128 v16, v[48:51] offset:256
L_comb2:
    s_cmp_lg_u32 s26, 0
    s_cbranch_scc1 L_slow110
    s_waitcnt vmcnt(0) lgkmcnt(0)
    s_barrier
    ds_read_b64 v[64:65], v17 offset:0
    ds_read_b64 v[66:67], v17 offset:4224
    ds_read_b64 v[68:69], v17 offset:8448
    ds_read_b64 v[70:71], v17 offset:12672
    s_mov_b64 exec, 1
    buffer_store_dwordx2 v[14:15], v1, s[16:19], s61 offen
    s_mov_b64 exec, -1
    s_waitcnt lgkmcnt(3)
    v_pk_mul_f32 v[64:65], v[64:65], v[20:21] op_sel:[0,0] op_sel_hi:[1,0]
    s_waitcnt lgkmcnt(2)
    v_pk_fma_f32 v[64:65], v[66:67], v[20:21], v[64:65] op_sel:[0,1,0] op_sel_hi:[1,1,1]
    s_waitcnt lgkmcnt(1)
    v_pk_fma_f32 v[64:65], v[68:69], v[22:23], v[64:65] op_sel:[0,0,0] op_sel_hi:[1,0,1]
    s_waitcnt lgkmcnt(0)
    v_pk_fma_f32 v[64:65], v[70:71], v[22:23], v[64:65] op_sel:[0,1,0] op_sel_hi:[1,1,1]
    v_cvt_pk_bf16_f32 v64, v64, v65
    buffer_load_dwordx2 v[76:77], v11, s[16:19], s64 offen sc1
    buffer_store_dword v64, v18, s[16:19], s60 offen
L_slow110b:
    v_mov_b64 v[56:57], 0
    v_mov_b64 v[58:59], 0
    v_mov_b64 v[60:61], 0
    v_mov_b64 v[62:63], 0
    v_mov_b32 v20, 0x3f803f80
    v_mov_b32 v21, 0x3f803f80
    v_mov_b32 v22, 0x3f803f80
    v_mov_b32 v23, 0x3f803f80
    buffer_load_dwordx2 v[76:77], v11, s[16:19], s64 offen sc1
    s_lshl_b32 s28, s3, 8
    s_add_u32 s28, s28, 156288
L_pad4:
    s_cbranch_execz L_ret
    v_lshrrev_b32 v72, 2, v1
    v_add_u32 v72, s28, v72
    v_lshrrev_b32 v73, 8, v1
    v_and_b32 v73, 1, v73
    v_lshlrev_b32 v73, 5, v73
    v_and_b32 v13, 0xc0, v1
    v_add_u32 v73, v73, v13
    v_and_b32 v13, 0x30, v1
    v_lshrrev_b32 v13, 1, v13
    v_add_u32 v73, v73, v13
    v_add_u32 v73, 156288, v73
    ds_read_b64 v[14:15], v73 offset:1024
    v_and_b32 v74, 0x100, v1
    v_and_b32 v13, 0xf0, v1
    v_lshrrev_b32 v13, 2, v13
    v_add_u32 v74, v74, v13
    v_and_b32 v75, 16, v1
    v_lshlrev_b32 v75, 9, v75
    v_and_b32 v13, 32, v1
    v_lshl_add_u32 v75, v13, 6, v75
    s_waitcnt vmcnt(2)
L_os_c:
    v_max_u32 v13, v76, v77
    v_cmp_eq_u32 vcc, 0xffbfffbf, v13
    s_cbranch_vccnz L_os_l
L_os_g:
    buffer_load_dwordx4 v[24:27], v1, s[16:19], s62 offen offset:0 sc1
    buffer_load_dwordx4 v[28:31], v1, s[16:19], s62 offen offset:1024 sc1
    s_barrier
    buffer_load_dwordx4 v[32:35], v1, s[16:19], s62 offen offset:2048 sc1
    buffer_load_dwordx4 v[36:39], v1, s[16:19], s62 offen offset:3072 sc1
    s_barrier
    buffer_load_dwordx4 v[40:43], v1, s[16:19], s63 offen offset:0 sc1
    buffer_load_dwordx4 v[44:47], v1, s[16:19], s63 offen offset:1024 sc1
    s_barrier
    buffer_load_dwordx4 v[48:51], v1, s[16:19], s63 offen offset:2048 sc1
    buffer_load_dwordx4 v[52:55], v1, s[16:19], s63 offen offset:3072 sc1
    s_mov_b32 s90, 0
    v_max_f32_dpp v10, v76, v76 row_ror:4 row_mask:0xf bank_mask:0xf
    v_mov_b32 v12, v10
    s_nop 1
    v_permlane16_swap_b32 v12, v10
    v_max_f32 v10, v12, v10
    v_mov_b32 v12, v10
    s_nop 1
    v_permlane32_swap_b32 v12, v10
    v_max_f32 v10, v12, v10
    v_sub_f32 v78, v76, v10
    v_exp_f32 v78, v78
    s_nop 0
    v_mul_f32 v79, v78, v77
    s_nop 1
    v_add_f32_dpp v79, v79, v79 row_ror:4 row_mask:0xf bank_mask:0xf
    v_mov_b32 v12, v79
    s_nop 1
    v_permlane16_swap_b32 v12, v79
    v_add_f32 v79, v12, v79
    v_mov_b32 v12, v79
    s_nop 1
    v_permlane32_swap_b32 v12, v79
    v_add_f32 v79, v12, v79
    v_rcp_f32 v79, v79
    s_nop 0
    v_mul_f32 v78, v78, v79
    s_waitcnt vmcnt(6)
    v_max3_u32 v13, v24, v25, v26
    v_max3_u32 v13, v13, v27, v28
    v_max3_u32 v13, v13, v29, v30
    v_max_u32 v13, v13, v31
    v_cmp_eq_u32 vcc, 0xffbfffbf, v13
    s_cbranch_vccnz L_o_r0
    v_mfma_f32_16x16x32_bf16 v[56:59], v[24:27], v[96:99], v[56:59]
    v_mfma_f32_16x16x32_bf16 v[60:63], v[28:31], v[96:99], v[60:63]
L_o_n0:
    s_waitcnt vmcnt(4)
    v_max3_u32 v13, v32, v33, v34
    v_max3_u32 v13, v13, v35, v36
    v_max3_u32 v13, v13, v37, v38
    v_max_u32 v13, v13, v39
    v_cmp_eq_u32 vcc, 0xffbfffbf, v13
    s_cbranch_vccnz L_o_r1
    v_mfma_f32_16x16x32_bf16 v[56:59], v[32:35], v[100:103], v[56:59]
    v_mfma_f32_16x16x32_bf16 v[60:63], v[36:39], v[100:103], v[60:63]
L_o_n1:
    s_waitcnt vmcnt(2)
    v_max3_u32 v13, v40, v41, v42
    v_max3_u32 v13, v13, v43, v44
    v_max3_u32 v13, v13, v45, v46
    v_max_u32 v13, v13, v47
    v_cmp_eq_u32 vcc, 0xffbfffbf, v13
    s_cbranch_vccnz L_o_r2
    v_mfma_f32_16x16x32_bf16 v[56:59], v[40:43], v[104:107], v[56:59]
    v_mfma_f32_16x16x32_bf16 v[60:63], v[44:47], v[104:107], v[60:63]
L_o_n2:
    s_mov_b64 exec, 15
    buffer_store_dword v1, v75, s[16:19], s91 offen sc1
    s_mov_b64 exec, -1
    s_cmp_lg_u32 s90, 0
    s_cbranch_scc1 L_o_enter
    s_waitcnt vmcnt(1)
    v_mfma_f32_16x16x32_bf16 v[64:67], v[48:51], v[108:111], v[56:59]
    v_mfma_f32_16x16x32_bf16 v[68:71], v[52:55], v[108:111], v[60:63]
    v_max3_u32 v13, v48, v49, v50
    v_max3_u32 v13, v13, v51, v52
    v_max3_u32 v13, v13, v53, v54
    v_max_u32 v13, v13, v55
    v_cmp_eq_u32 vcc, 0xffbfffbf, v13
    s_cbranch_vccnz L_o_enter
L_o_done:
    s_nop 0
    v_mul_f32_dpp v56, v78, v64 row_newbcast:0 row_mask:0xf bank_mask:0xf
    v_mul_f32_dpp v57, v78, v65 row_newbcast:1 row_mask:0xf bank_mask:0xf
    v_mul_f32_dpp v58, v78, v66 row_newbcast:2 row_mask:0xf bank_mask:0xf
    v_mul_f32_dpp v59, v78, v67 row_newbcast:3 row_mask:0xf bank_mask:0xf
    v_fmac_f32_dpp v56, v78, v68 row_newbcast:4 row_mask:0xf bank_mask:0xf
    v_fmac_f32_dpp v57, v78, v69 row_newbcast:5 row_mask:0xf bank_mask:0xf
    v_fmac_f32_dpp v58, v78, v70 row_newbcast:6 row_mask:0xf bank_mask:0xf
    v_fmac_f32_dpp v59, v78, v71 row_newbcast:7 row_mask:0xf bank_mask:0xf
    s_nop 0
    v_permlane32_swap_b32 v56, v58
    v_permlane32_swap_b32 v57, v59
    v_pk_add_f32 v[56:57], v[56:57], v[58:59]
    s_nop 1
    v_permlane16_swap_b32 v56, v57
    v_add_f32 v56, v56, v57
    ds_write_b32 v72, v56
    s_cmp_lg_u32 s3, 0
    s_cbranch_scc1 L_o_oth
    s_mov_b32 exec_hi, 0
    s_waitcnt lgkmcnt(0)
    s_barrier
    ds_read2_b64 v[56:59], v73 offset0:0 offset1:32
    ds_read2_b64 v[76:79], v73 offset0:64 offset1:96
    s_waitcnt lgkmcnt(1)
    v_pk_add_f32 v[56:57], v[56:57], v[58:59]
    v_pk_add_f32 v[56:57], v[56:57], v[14:15]
    s_waitcnt lgkmcnt(0)
    v_pk_add_f32 v[76:77], v[76:77], v[78:79]
    v_pk_add_f32 v[56:57], v[56:57], v[76:77]
    v_cvt_pk_bf16_f32 v58, v56, v57
    buffer_store_dword v58, v74, s[16:19], s65 offen sc1
    buffer_store_dword v58, v74, s[16:19], s101 offen sc1
    ds_write_b64 v73, v[56:57] offset:1024
    s_mov_b64 exec, -1
L_o_join:
    s_barrier
    v_and_b32 v13, 0xf0, v1
    v_add_u32 v13, 157952, v13
    ds_read_b128 v[64:67], v13
    s_waitcnt lgkmcnt(0)
    v_add_f32 v64, v64, v65
    v_add_f32 v66, v66, v67
    v_add_f32 v64, v64, v66
    v_mul_f32 v10, 0x3b000000, v64
    v_and_b32 v73, 0x30, v1
    v_and_b32 v74, 0x40, v1
    v_cmp_ne_u32 vcc, 0, v74
    v_xor_b32 v13, 0x30, v73
    s_nop 0
    v_cndmask_b32 v13, v73, v13, vcc
    v_add_u32 v13, v13, v74
    v_and_b32 v74, 0x180, v1
    v_add_u32 v13, v13, v74
    v_lshrrev_b32 v13, 1, v13
    v_lshrrev_b32 v74, 3, v74
    v_lshrrev_b32 v73, 2, v73
    v_add_u32 v74, v74, v73
    v_add_u32 v73, 156288, v13
    v_and_b32 v75, 0x300, v1
    v_and_b32 v76, 0x200, v1
    v_add_u32 v75, v75, v76
    v_and_b32 v76, 0xf0, v1
    v_lshrrev_b32 v76, 1, v76
    v_add_u32 v75, v75, v76
    v_add_u32 v75, 131072, v75
    s_waitcnt vmcnt(1)
L_wdw_b:
    s_cmp_lg_u32 s3, 3
    s_cbranch_scc1 L_hy_e
    v_mov_b32 v12, 0xffbfffbf
    s_mov_b64 exec, s[46:47]
L_hy_l:
    buffer_load_dword v12, v14, s[16:19], s92 offen offset:2048 sc1
    s_sub_u32 s27, s27, 1
    s_cbranch_scc1 L_hy_x
    s_waitcnt vmcnt(3)
    v_min_u32 v13, v15, v12
    v_cmp_eq_u32 vcc, 0xffbfffbf, v13
L_pad5:
    s_cbranch_execz L_ret
    s_cbranch_vccnz L_hy_l
L_hy_g:
    s_mov_b64 exec, -1
L_hy_e:
    s_waitcnt lgkmcnt(0)
    s_barrier
    buffer_load_dwordx4 v[24:27], v1, s[16:19], s67 offen offset:0 sc1
    buffer_load_dwordx4 v[28:31], v1, s[16:19], s67 offen offset:1024 sc1
    s_barrier
    buffer_load_dwordx4 v[32:35], v1, s[16:19], s67 offen offset:2048 sc1
    buffer_load_dwordx4 v[36:39], v1, s[16:19], s67 offen offset:3072 sc1
    s_barrier
    buffer_load_dwordx4 v[40:43], v1, s[16:19], s68 offen offset:0 sc1
    buffer_load_dwordx4 v[44:47], v1, s[16:19], s68 offen offset:1024 sc1
    s_barrier
    buffer_load_dwordx4 v[48:51], v1, s[16:19], s68 offen offset:2048 sc1
    buffer_load_dwordx4 v[52:55], v1, s[16:19], s68 offen offset:3072 sc1
    s_mov_b32 s90, 0
    v_mov_b64 v[56:57], 0
    v_mov_b64 v[58:59], 0
    v_mov_b64 v[60:61], 0
    v_mov_b64 v[62:63], 0
    v_mov_b64 v[64:65], 0
    v_mov_b64 v[66:67], 0
    s_waitcnt vmcnt(6)
    v_max3_u32 v13, v24, v25, v26
    v_max3_u32 v13, v13, v27, v28
    v_max3_u32 v13, v13, v29, v30
    v_max_u32 v13, v13, v31
    v_cmp_eq_u32 vcc, 0xffbfffbf, v13
    s_cbranch_vccnz L_f_r0
    v_mfma_f32_16x16x32_bf16 v[60:63], v[24:27], v[20:23], v[60:63]
    v_mfma_f32_16x16x32_bf16 v[56:59], v[24:27], v[112:115], v[56:59]
    v_mfma_f32_16x16x32_bf16 v[64:67], v[24:27], v[24:27], v[64:67]
    v_mfma_f32_16x16x32_bf16 v[60:63], v[28:31], v[20:23], v[60:63]
    v_mfma_f32_16x16x32_bf16 v[56:59], v[28:31], v[116:119], v[56:59]
    v_mfma_f32_16x16x32_bf16 v[64:67], v[28:31], v[28:31], v[64:67]
L_f_n0:
    s_waitcnt vmcnt(4)
    v_max3_u32 v13, v32, v33, v34
    v_max3_u32 v13, v13, v35, v36
    v_max3_u32 v13, v13, v37, v38
    v_max_u32 v13, v13, v39
    v_cmp_eq_u32 vcc, 0xffbfffbf, v13
    s_cbranch_vccnz L_f_r1
    v_mfma_f32_16x16x32_bf16 v[60:63], v[32:35], v[20:23], v[60:63]
    v_mfma_f32_16x16x32_bf16 v[56:59], v[32:35], v[120:123], v[56:59]
    v_mfma_f32_16x16x32_bf16 v[64:67], v[32:35], v[32:35], v[64:67]
    v_mfma_f32_16x16x32_bf16 v[60:63], v[36:39], v[20:23], v[60:63]
    v_mfma_f32_16x16x32_bf16 v[56:59], v[36:39], v[124:127], v[56:59]
    v_mfma_f32_16x16x32_bf16 v[64:67], v[36:39], v[36:39], v[64:67]
L_f_n1:
    s_waitcnt vmcnt(2)
    v_max3_u32 v13, v40, v41, v42
    v_max3_u32 v13, v13, v43, v44
    v_max3_u32 v13, v13, v45, v46
    v_max_u32 v13, v13, v47
    v_cmp_eq_u32 vcc, 0xffbfffbf, v13
    s_cbranch_vccnz L_f_r2
    v_mfma_f32_16x16x32_bf16 v[60:63], v[40:43], v[20:23], v[60:63]
    v_mfma_f32_16x16x32_bf16 v[56:59], v[40:43], v[112:115], v[56:59]
    v_mfma_f32_16x16x32_bf16 v[60:63], v[44:47], v[20:23], v[60:63]
    v_mfma_f32_16x16x32_bf16 v[56:59], v[44:47], v[116:119], v[56:59]
L_f_n2:
    s_cmp_lg_u32 s90, 0
    s_cbranch_scc1 L_f_enter
    s_waitcnt vmcnt(0)
    v_mfma_f32_16x16x32_bf16 v[68:71], v[48:51], v[20:23], v[60:63]
    v_max3_u32 v13, v48, v49, v50
    v_mfma_f32_16x16x32_bf16 v[76:79], v[48:51], v[120:123], v[56:59]
    v_max3_u32 v13, v13, v51, v52
    v_mfma_f32_16x16x32_bf16 v[68:71], v[52:55], v[20:23], v[68:71]
    v_mfma_f32_16x16x32_bf16 v[76:79], v[52:55], v[124:127], v[76:79]
    v_max3_u32 v13, v13, v53, v54
    v_max_u32 v13, v13, v55
    v_cmp_eq_u32 vcc, 0xffbfffbf, v13
    s_cbranch_vccnz L_f_enter
L_f_done:
    s_nop 3
    v_pk_fma_f32 v[76:77], v[68:69], v[10:11], v[76:77] op_sel_hi:[1,0,1] neg_lo:[1,0,0] neg_hi:[1,0,0]
    v_pk_fma_f32 v[78:79], v[70:71], v[10:11], v[78:79] op_sel_hi:[1,0,1] neg_lo:[1,0,0] neg_hi:[1,0,0]
    s_nop 1
    v_permlane32_swap_b32 v76, v78
    v_permlane32_swap_b32 v77, v79
    v_pk_add_f32 v[76:77], v[76:77], v[78:79]
    s_nop 1
    v_permlane16_swap_b32 v76, v77
    v_add_f32 v76, v76, v77
    ds_write_b32 v72, v76
    s_cmp_lg_u32 s3, 0
    v_mfma_f32_16x16x32_bf16 v[60:63], v[24:27], v[40:43], 0
    v_mfma_f32_16x16x32_bf16 v[64:67], v[40:43], v[40:43], v[64:67]
    v_mfma_f32_16x16x32_bf16 v[60:63], v[28:31], v[44:47], v[60:63]
    v_mfma_f32_16x16x32_bf16 v[64:67], v[44:47], v[44:47], v[64:67]
    s_cbranch_scc1 L_f_oth
    s_waitcnt lgkmcnt(0)
    s_barrier
    ds_read2_b64 v[56:59], v73 offset0:0 offset1:32
    ds_read2_b64 v[76:79], v73 offset0:64 offset1:96
    v_mfma_f32_16x16x32_bf16 v[60:63], v[32:35], v[48:51], v[60:63]
    v_mfma_f32_16x16x32_bf16 v[64:67], v[48:51], v[48:51], v[64:67]
    v_mfma_f32_16x16x32_bf16 v[60:63], v[36:39], v[52:55], v[60:63]
    v_mfma_f32_16x16x32_bf16 v[64:67], v[52:55], v[52:55], v[64:67]
    s_cmp_lg_u32 s26, 0
    s_cbranch_scc1 L_slow111
    s_waitcnt lgkmcnt(1)
    v_pk_add_f32 v[56:57], v[56:57], v[58:59]
    s_waitcnt lgkmcnt(0)
    v_pk_add_f32 v[76:77], v[76:77], v[78:79]
    v_pk_add_f32 v[56:57], v[56:57], v[76:77]
    s_nop 1
    v_mul_f32_dpp v56, v56, v56 row_half_mirror row_mask:0xf bank_mask:0xf
    v_mul_f32_dpp v57, v57, v57 row_half_mirror row_mask:0xf bank_mask:0xf
    s_mov_b64 exec, 0x0f0f0f0f
    v_cvt_pk_bf16_f32 v58, v56, v57
    buffer_store_dword v58, v74, s[16:19], s71 offen
    s_mov_b64 exec, -1
L_slow111b:
L_f_com:
    v_permlane32_swap_b32 v68, v70
    v_permlane32_swap_b32 v69, v71
    v_pk_add_f32 v[68:69], v[68:69], v[70:71]
    v_pk_fma_f32 v[64:65], v[60:61], 2.0, v[64:65] op_sel_hi:[1,0,1]
    v_pk_fma_f32 v[66:67], v[62:63], 2.0, v[66:67] op_sel_hi:[1,0,1]
    v_lshrrev_b32 v13, 8, v1
    s_lshl_b32 s28, s3, 2
    v_permlane32_swap_b32 v64, v66
    v_permlane32_swap_b32 v65, v67
    v_pk_add_f32 v[64:65], v[64:65], v[66:67]
    v_permlane16_swap_b32 v68, v69
    v_add_f32 v68, v68, v69
    v_permlane16_swap_b32 v64, v65
    v_add_f32 v64, v64, v65
    s_add_u32 s28, s28, 157568
    v_lshl_add_u32 v13, v13, 4, s28
    v_add_f32_dpp v64, v64, v64 row_ror:4 row_mask:0xf bank_mask:0xf
    s_nop 1
    v_add_f32_dpp v64, v64, v64 row_ror:8 row_mask:0xf bank_mask:0xf
    s_mov_b64 exec, s[80:81]
    ds_write2_b32 v13, v68, v64 offset0:0 offset1:16
    s_mov_b64 exec, -1
    s_waitcnt lgkmcnt(0)
    s_barrier
    s_branch L_f2_skip
L_f_23:
    s_nop 2
    s_branch L_f_com
L_f_oth:
    s_waitcnt lgkmcnt(0)
    s_barrier
    s_cmp_lg_u32 s3, 1
    v_mfma_f32_16x16x32_bf16 v[60:63], v[32:35], v[48:51], v[60:63]
    v_mfma_f32_16x16x32_bf16 v[64:67], v[48:51], v[48:51], v[64:67]
    v_mfma_f32_16x16x32_bf16 v[60:63], v[36:39], v[52:55], v[60:63]
    v_mfma_f32_16x16x32_bf16 v[64:67], v[52:55], v[52:55], v[64:67]
    s_cbranch_scc1 L_f_23
    ds_read_b64_tr_b16 v[24:25], v75 offset:0
    ds_read_b64_tr_b16 v[26:27], v75 offset:128
    ds_read_b64_tr_b16 v[40:41], v75 offset:4096
    ds_read_b64_tr_b16 v[42:43], v75 offset:4224
    ds_read_b64_tr_b16 v[28:29], v75 offset:512
    ds_read_b64_tr_b16 v[30:31], v75 offset:640
    ds_read_b64_tr_b16 v[44:45], v75 offset:4608
    ds_read_b64_tr_b16 v[46:47], v75 offset:4736
    ds_read_b64_tr_b16 v[32:33], v75 offset:2048
    ds_read_b64_tr_b16 v[34:35], v75 offset:2176
    ds_read_b64_tr_b16 v[48:49], v75 offset:6144
    ds_read_b64_tr_b16 v[50:51], v75 offset:6272
    ds_read_b64_tr_b16 v[36:37], v75 offset:2560
    ds_read_b64_tr_b16 v[38:39], v75 offset:2688
    v_permlane32_swap_b32 v68, v70
    v_permlane32_swap_b32 v69, v71
L_pad6:
    s_cbranch_execz L_ret
    v_pk_add_f32 v[68:69], v[68:69], v[70:71]
    v_pk_fma_f32 v[64:65], v[60:61], 2.0, v[64:65] op_sel_hi:[1,0,1]
    v_pk_fma_f32 v[66:67], v[62:63], 2.0, v[66:67] op_sel_hi:[1,0,1]
    v_lshrrev_b32 v13, 8, v1
    s_lshl_b32 s28, s3, 2
    v_permlane32_swap_b32 v64, v66
    v_permlane32_swap_b32 v65, v67
    v_pk_add_f32 v[64:65], v[64:65], v[66:67]
    v_permlane16_swap_b32 v68, v69
    v_add_f32 v68, v68, v69
    v_permlane16_swap_b32 v64, v65
    v_add_f32 v64, v64, v65
    s_add_u32 s28, s28, 157568
    v_lshl_add_u32 v13, v13, 4, s28
    v_add_f32_dpp v64, v64, v64 row_ror:4 row_mask:0xf bank_mask:0xf
    s_nop 1
    v_add_f32_dpp v64, v64, v64 row_ror:8 row_mask:0xf bank_mask:0xf
    s_mov_b64 exec, s[80:81]
    ds_write2_b32 v13, v68, v64 offset0:0 offset1:16
    s_mov_b64 exec, -1
    v_and_b32 v13, 0x30, v1
    v_lshrrev_b32 v12, 8, v1
    v_lshlrev_b32 v14, 4, v12
    v_lshl_add_u32 v14, v13, 2, v14
    v_add_u32 v14, 157312, v14
    ds_read_b128 v[76:79], v14
    v_subrev_u32 v10, 157312, v14
    v_and_b32 v15, 1, v12
    v_lshl_add_u32 v15, v15, 3, v13
    v_lshrrev_b32 v12, 1, v12
    v_lshl_add_u32 v15, v12, 8, v15
    v_add_u32 v12, 157568, v13
    s_waitcnt lgkmcnt(0)
    buffer_load_dwordx4 v[52:55], v1, s[16:19], s72 offen sc1
    buffer_load_dwordx4 v[56:59], v1, s[16:19], s72 offen offset:1024 sc1
    s_barrier
    buffer_load_dwordx4 v[52:55], v1, s[16:19], s72 offen sc1
    buffer_load_dwordx4 v[56:59], v1, s[16:19], s72 offen offset:1024 sc1
    ds_read_b128 v[60:63], v12
    ds_read_b128 v[64:67], v12 offset:64
    s_waitcnt lgkmcnt(0)
    v_pk_add_f32 v[60:61], v[60:61], v[62:63]
    v_pk_add_f32 v[64:65], v[64:65], v[66:67]
    v_add_f32 v60, v60, v61
    v_add_f32 v64, v64, v65
    v_mul_f32 v61, 0x3b000000, v60
    v_mul_f32 v64, 0x3b000000, v64
    v_fma_f32 v64, -v61, v61, v64
    v_max_f32 v64, 0, v64
    v_add_f32 v64, 0x3727c5ac, v64
    v_rcp_f32 v12, v64
    s_waitcnt vmcnt(2)
L_h_c:
    v_max3_u32 v13, v52, v53, v54
    v_max3_u32 v13, v13, v55, v56
    v_max3_u32 v13, v13, v57, v58
    v_max_u32 v13, v13, v59
    v_cmp_eq_u32 vcc, 0xffbfffbf, v13
    s_cbranch_vccnz L_h_2
L_h_g:
    v_mfma_f32_16x16x32_bf16 v[60:63], v[24:27], v[52:55], 0
    v_mfma_f32_16x16x32_bf16 v[64:67], v[28:31], v[52:55], 0
    v_mfma_f32_16x16x32_bf16 v[60:63], v[40:43], v[56:59], v[60:63]
    v_mfma_f32_16x16x32_bf16 v[64:67], v[44:47], v[56:59], v[64:67]
    v_mfma_f32_16x16x32_bf16 v[72:75], v[36:39], v[52:55], 0
    v_mfma_f32_16x16x32_bf16 v[68:71], v[32:35], v[52:55], 0
    v_mfma_f32_16x16x32_bf16 v[68:71], v[48:51], v[56:59], v[68:71]
    s_cmp_lg_u32 s7, 0
    s_cbranch_scc1 L_final
    s_nop 2
    v_add_f32_dpp v60, v64, v60 row_ror:12 row_mask:0xf bank_mask:0xf
    v_add_f32_dpp v61, v65, v61 row_ror:12 row_mask:0xf bank_mask:0xf
    v_add_f32_dpp v62, v66, v62 row_ror:12 row_mask:0xf bank_mask:0xf
    v_add_f32_dpp v63, v67, v63 row_ror:12 row_mask:0xf bank_mask:0xf
    v_add_f32_dpp v60, v72, v60 row_ror:4 row_mask:0xf bank_mask:0xf
    v_add_f32_dpp v61, v73, v61 row_ror:4 row_mask:0xf bank_mask:0xf
    v_add_f32_dpp v62, v74, v62 row_ror:4 row_mask:0xf bank_mask:0xf
    v_add_f32_dpp v63, v75, v63 row_ror:4 row_mask:0xf bank_mask:0xf
    v_add_f32_dpp v60, v68, v60 row_ror:8 row_mask:0xf bank_mask:0xf
    v_add_f32_dpp v61, v69, v61 row_ror:8 row_mask:0xf bank_mask:0xf
    v_add_f32_dpp v62, v70, v62 row_ror:8 row_mask:0xf bank_mask:0xf
    v_add_f32_dpp v63, v71, v63 row_ror:8 row_mask:0xf bank_mask:0xf
    s_mov_b64 exec, s[78:79]
    v_pk_fma_f32 v[76:77], v[60:61], v[12:13], v[76:77] op_sel_hi:[1,0,1]
    v_pk_fma_f32 v[78:79], v[62:63], v[12:13], v[78:79] op_sel_hi:[1,0,1]
    v_cvt_pk_bf16_f32 v60, v76, v77
    v_cvt_pk_bf16_f32 v61, v78, v79
    buffer_store_dwordx2 v[60:61], v15, s[16:19], s66 offen sc1
    buffer_store_dwordx2 v[60:61], v15, s[16:19], s95 offen sc1
    ds_write_b128 v14, v[76:79]
    s_mov_b64 exec, -1
L_f2_skip:
    s_cmp_lg_u32 s7, 0
    s_cbranch_scc1 L_exit
    v_and_b32 v13, 0xf0, v1
    v_add_u32 v13, 157696, v13
    ds_read_b128 v[64:67], v13
    s_waitcnt lgkmcnt(0)
    v_add_f32 v64, v64, v65
    v_add_f32 v66, v66, v67
    v_add_f32 v64, v64, v66
    v_mul_f32 v10, 0x3b000000, v64
    s_lshl_b32 s28, s3, 8
    s_add_u32 s28, s28, 156288
    v_lshrrev_b32 v72, 2, v1
    v_add_u32 v72, s28, v72
    v_and_b32 v74, 0xc0, v1
    v_lshlrev_b32 v74, 4, v74
    v_bfe_u32 v13, v1, 4, 2
    v_lshl_add_u32 v74, v13, 2, v74
    v_bfe_u32 v13, v1, 8, 1
    v_lshl_add_u32 v74, v13, 5, v74
    v_and_b32 v73, 0xf0, v1
    v_lshl_add_u32 v73, v13, 3, v73
    v_add_u32 v73, 156288, v73
    s_xor_b32 s30, s5, 0
    s_lshl_b32 s32, s4, 12
    s_and_b32 s28, s30, 3
    s_lshl_b32 s28, s28, 8
    s_add_u32 s32, s32, s28
    s_and_b32 s28, s30, 4
    s_lshl_b32 s28, s28, 5
    s_add_u32 s32, s32, s28
    s_and_b32 s28, s30, 16
    s_lshl_b32 s28, s28, 2
    s_add_u32 s32, s32, s28
    s_and_b32 s28, s30, 8
    s_lshl_b32 s28, s28, 1
    s_add_u32 s32, s32, s28
    s_add_u32 s32, s32, 360448
    s_add_u32 s33, s74, 360448
    v_bfe_u32 v13, v1, 9, 1
    v_mul_u32_u24 v13, 576, v13
    v_add_u32 v12, s83, v13
    v_bfe_u32 v13, v1, 5, 1
    v_mul_u32_u24 v13, 288, v13
    v_add_u32 v12, v12, v13
    v_bfe_u32 v13, v1, 7, 1
    v_mul_u32_u24 v13, 144, v13
    v_add_u32 v12, v12, v13
    v_bfe_u32 v13, v1, 4, 1
    v_lshl_add_u32 v12, v13, 6, v12
    v_bfe_u32 v13, v1, 8, 1
    v_lshl_add_u32 v12, v13, 5, v12
    v_bfe_u32 v13, v1, 6, 1
    v_lshl_add_u32 v12, v13, 3, v12
    s_add_u32 s28, s83, 128
    v_bfe_u32 v13, v1, 4, 2
    v_mul_u32_u24 v13, 576, v13
    v_add_u32 v75, s28, v13
    v_mov_b64 v[68:69], 0
    v_mov_b64 v[70:71], 0
    ds_write_b128 v75, v[68:71]
    v_bfe_u32 v13, v1, 8, 2
    v_mul_u32_u24 v13, 144, v13
    v_add_u32 v75, s83, v13
    v_bfe_u32 v13, v1, 5, 1
    v_lshl_add_u32 v75, v13, 6, v75
    v_bfe_u32 v13, v1, 6, 1
    v_lshl_add_u32 v75, v13, 5, v75
    v_bfe_u32 v13, v1, 4, 1
    v_lshl_add_u32 v75, v13, 4, v75
L_pad7:
    s_cbranch_execz L_ret
    v_mov_b32 v13, s28
    s_nop 1
    v_mov_b32_dpp v75, v13 quad_perm:[0,1,2,3] row_mask:0xf bank_mask:0xc
    s_add_u32 s28, s83, 2048
    v_bfe_u32 v13, v1, 8, 1
    v_mul_u32_u24 v13, 1056, v13
    v_add_u32 v16, s28, v13
    v_bfe_u32 v13, v1, 9, 1
    v_lshl_add_u32 v16, v13, 6, v16
    v_bfe_u32 v13, v1, 4, 4
    v_lshl_add_u32 v16, v13, 2, v16
    s_lshl_b32 s28, s3, 3
    s_add_u32 s28, s28, 156160
    v_bfe_u32 v13, v1, 8, 1
    v_lshl_add_u32 v19, v13, 6, s28
    v_bfe_u32 v13, v1, 9, 1
    v_lshl_add_u32 v19, v13, 5, v19
    s_mov_b32 s28, 0x4444
    v_bfe_u32 v13, v1, 5, 1
    v_mul_u32_u24 v13, 43690, v13
    v_add_u32 v15, s28, v13
    s_add_u32 s67, s67, 196608
    s_add_u32 s68, s68, 196608
    s_add_u32 s65, s65, 196608
    s_add_u32 s101, s101, 196608
    s_add_u32 s64, s64, 8192
    s_add_u32 s61, s61, 8192
    s_add_u32 s72, s72, 16384
    s_add_u32 s71, s71, 16384
    s_add_u32 s91, s91, 1024
    s_add_u32 s92, s92, 1024
    s_lshl_b32 s50, s3, 5
    s_add_u32 s50, s50, 156160
    s_lshl_b32 s51, s6, 4
    s_add_u32 s51, s51, 157568
    s_mov_b32 s53, 0
    s_cmp_lg_u32 s3, 1
    s_cbranch_scc1 L_x_na
    s_waitcnt vmcnt(1)
L_x_na:
    s_waitcnt lgkmcnt(0)
    s_barrier
    buffer_load_dwordx4 v[24:27], v1, s[16:19], s69 offen offset:0 sc1
    buffer_load_dwordx4 v[28:31], v1, s[16:19], s69 offen offset:1024 sc1
    s_barrier
    buffer_load_dwordx4 v[32:35], v1, s[16:19], s69 offen offset:2048 sc1
    buffer_load_dwordx4 v[36:39], v1, s[16:19], s69 offen offset:3072 sc1
    s_barrier
    buffer_load_dwordx4 v[40:43], v1, s[16:19], s70 offen offset:0 sc1
    buffer_load_dwordx4 v[44:47], v1, s[16:19], s70 offen offset:1024 sc1
    s_barrier
    buffer_load_dwordx4 v[48:51], v1, s[16:19], s70 offen offset:2048 sc1
    buffer_load_dwordx4 v[52:55], v1, s[16:19], s70 offen offset:3072 sc1
    s_mov_b32 s90, 0
    v_mov_b64 v[56:57], 0
    v_mov_b64 v[58:59], 0
    v_mov_b64 v[60:61], 0
    v_mov_b64 v[62:63], 0
    v_mov_b64 v[64:65], 0
    v_mov_b64 v[66:67], 0
    s_waitcnt vmcnt(6)
    v_max3_u32 v13, v24, v25, v26
    v_max3_u32 v13, v13, v27, v28
    v_max3_u32 v13, v13, v29, v30
    v_max_u32 v13, v13, v31
    v_cmp_eq_u32 vcc, 0xffbfffbf, v13
    s_cbranch_vccnz L_q_r0
    v_mfma_f32_16x16x32_bf16 v[60:63], v[24:27], v[20:23], v[60:63]
    v_mfma_f32_16x16x32_bf16 v[56:59], v[24:27], v[80:83], v[56:59]
    v_mfma_f32_16x16x32_bf16 v[64:67], v[24:27], v[24:27], v[64:67]
    v_mfma_f32_16x16x32_bf16 v[60:63], v[28:31], v[20:23], v[60:63]
    v_mfma_f32_16x16x32_bf16 v[56:59], v[28:31], v[84:87], v[56:59]
    v_mfma_f32_16x16x32_bf16 v[64:67], v[28:31], v[28:31], v[64:67]
L_q_n0:
    s_waitcnt vmcnt(4)
    v_max3_u32 v13, v32, v33, v34
    v_max3_u32 v13, v13, v35, v36
    v_max3_u32 v13, v13, v37, v38
    v_max_u32 v13, v13, v39
    v_cmp_eq_u32 vcc, 0xffbfffbf, v13
    s_cbranch_vccnz L_q_r1
    v_mfma_f32_16x16x32_bf16 v[60:63], v[32:35], v[20:23], v[60:63]
    v_mfma_f32_16x16x32_bf16 v[56:59], v[32:35], v[88:91], v[56:59]
    v_mfma_f32_16x16x32_bf16 v[64:67], v[32:35], v[32:35], v[64:67]
    v_mfma_f32_16x16x32_bf16 v[60:63], v[36:39], v[20:23], v[60:63]
    v_mfma_f32_16x16x32_bf16 v[56:59], v[36:39], v[92:95], v[56:59]
    v_mfma_f32_16x16x32_bf16 v[64:67], v[36:39], v[36:39], v[64:67]
L_q_n1:
    s_waitcnt vmcnt(2)
    v_max3_u32 v13, v40, v41, v42
    v_max3_u32 v13, v13, v43, v44
    v_max3_u32 v13, v13, v45, v46
    v_max_u32 v13, v13, v47
    v_cmp_eq_u32 vcc, 0xffbfffbf, v13
    s_cbranch_vccnz L_q_r2
    v_mfma_f32_16x16x32_bf16 v[60:63], v[40:43], v[20:23], v[60:63]
    v_mfma_f32_16x16x32_bf16 v[56:59], v[40:43], v[80:83], v[56:59]
    v_mfma_f32_16x16x32_bf16 v[60:63], v[44:47], v[20:23], v[60:63]
    v_mfma_f32_16x16x32_bf16 v[56:59], v[44:47], v[84:87], v[56:59]
L_q_n2:
    s_cmp_lg_u32 s90, 0
    s_cbranch_scc1 L_q_enter
    s_waitcnt vmcnt(0)
    v_mfma_f32_16x16x32_bf16 v[68:71], v[48:51], v[20:23], v[60:63]
    v_max3_u32 v13, v48, v49, v50
    v_mfma_f32_16x16x32_bf16 v[76:79], v[48:51], v[88:91], v[56:59]
    v_max3_u32 v13, v13, v51, v52
    v_mfma_f32_16x16x32_bf16 v[68:71], v[52:55], v[20:23], v[68:71]
    v_mfma_f32_16x16x32_bf16 v[76:79], v[52:55], v[92:95], v[76:79]
    v_max3_u32 v13, v13, v53, v54
    v_max_u32 v13, v13, v55
    v_cmp_eq_u32 vcc, 0xffbfffbf, v13
    s_cbranch_vccnz L_q_enter
L_q_done:
    s_nop 3
    v_pk_fma_f32 v[76:77], v[68:69], v[10:11], v[76:77] op_sel_hi:[1,0,1] neg_lo:[1,0,0] neg_hi:[1,0,0]
    v_pk_fma_f32 v[78:79], v[70:71], v[10:11], v[78:79] op_sel_hi:[1,0,1] neg_lo:[1,0,0] neg_hi:[1,0,0]
    s_nop 1
    v_permlane32_swap_b32 v76, v78
    v_permlane32_swap_b32 v77, v79
    v_pk_add_f32 v[76:77], v[76:77], v[78:79]
    s_nop 1
    v_permlane16_swap_b32 v76, v77
    v_add_f32 v76, v76, v77
    ds_write_b32 v72, v76
    s_cmp_lg_u32 s3, 0
    v_mfma_f32_16x16x32_bf16 v[60:63], v[24:27], v[40:43], 0
    v_mfma_f32_16x16x32_bf16 v[64:67], v[40:43], v[40:43], v[64:67]
    v_mfma_f32_16x16x32_bf16 v[60:63], v[28:31], v[44:47], v[60:63]
    v_mfma_f32_16x16x32_bf16 v[64:67], v[44:47], v[44:47], v[64:67]
    s_cbranch_scc1 L_q_oth
    s_waitcnt lgkmcnt(0)
    s_barrier
    ds_read2_b64 v[56:59], v73 offset0:0 offset1:32
    ds_read2_b64 v[76:79], v73 offset0:64 offset1:96
    v_mfma_f32_16x16x32_bf16 v[60:63], v[32:35], v[48:51], v[60:63]
    v_mfma_f32_16x16x32_bf16 v[64:67], v[48:51], v[48:51], v[64:67]
    v_mfma_f32_16x16x32_bf16 v[60:63], v[36:39], v[52:55], v[60:63]
    v_mfma_f32_16x16x32_bf16 v[64:67], v[52:55], v[52:55], v[64:67]
    s_cmp_lg_u32 s26, 0
    s_cbranch_scc1 L_slow112
    s_waitcnt lgkmcnt(1)
    v_pk_add_f32 v[56:57], v[56:57], v[58:59]
    s_waitcnt lgkmcnt(0)
    v_pk_add_f32 v[76:77], v[76:77], v[78:79]
    v_pk_add_f32 v[56:57], v[56:57], v[76:77]
    s_mov_b32 exec_hi, 0
    v_cvt_pk_bf16_f32 v58, v56, v57
    buffer_store_dword v58, v74, s[16:19], s32 offen
    s_mov_b64 exec, -1
L_slow112b:
    v_mov_b64 v[72:73], 0
    s_nop 1
    v_mfma_f32_32x32x8_bf16 v[24:39], v[72:73], v[72:73], 0
    v_permlane32_swap_b32 v68, v70
    v_permlane32_swap_b32 v69, v71
    v_pk_add_f32 v[68:69], v[68:69], v[70:71]
    v_pk_fma_f32 v[64:65], v[60:61], 2.0, v[64:65] op_sel_hi:[1,0,1]
    v_pk_fma_f32 v[66:67], v[62:63], 2.0, v[66:67] op_sel_hi:[1,0,1]
    v_lshrrev_b32 v13, 8, v1
    s_lshl_b32 s28, s3, 2
    v_permlane32_swap_b32 v64, v66
    v_permlane32_swap_b32 v65, v67
    v_pk_add_f32 v[64:65], v[64:65], v[66:67]
L_pad8:
    s_cbranch_execz L_ret
    v_permlane16_swap_b32 v68, v69
    v_add_f32 v68, v68, v69
    v_permlane16_swap_b32 v64, v65
    v_add_f32 v64, v64, v65
    s_add_u32 s28, s28, 157568
    v_lshl_add_u32 v13, v13, 4, s28
    v_add_f32_dpp v64, v64, v64 row_ror:4 row_mask:0xf bank_mask:0xf
    s_nop 1
    v_add_f32_dpp v64, v64, v64 row_ror:8 row_mask:0xf bank_mask:0xf
    s_mov_b64 exec, s[80:81]
    ds_write2_b32 v13, v68, v64 offset0:0 offset1:16
    s_mov_b64 exec, -1
    buffer_load_dwordx4 v[76:79], v1, s[16:19], s33 offen sc1
    s_branch L_q_join
L_q_oth:
    s_waitcnt lgkmcnt(0)
    s_barrier
    v_mfma_f32_16x16x32_bf16 v[60:63], v[32:35], v[48:51], v[60:63]
    v_mfma_f32_16x16x32_bf16 v[64:67], v[48:51], v[48:51], v[64:67]
    v_mfma_f32_16x16x32_bf16 v[60:63], v[36:39], v[52:55], v[60:63]
    v_mfma_f32_16x16x32_bf16 v[64:67], v[52:55], v[52:55], v[64:67]
    v_mov_b64 v[72:73], 0
    s_nop 1
    v_mfma_f32_32x32x8_bf16 v[24:39], v[72:73], v[72:73], 0
    v_permlane32_swap_b32 v68, v70
    v_permlane32_swap_b32 v69, v71
    v_pk_add_f32 v[68:69], v[68:69], v[70:71]
    v_lshrrev_b32 v13, 8, v1
    s_lshl_b32 s28, s3, 2
    v_permlane16_swap_b32 v68, v69
    v_pk_fma_f32 v[64:65], v[60:61], 2.0, v[64:65] op_sel_hi:[1,0,1]
    v_pk_fma_f32 v[66:67], v[62:63], 2.0, v[66:67] op_sel_hi:[1,0,1]
    v_add_f32 v68, v68, v69
    s_add_u32 s28, s28, 157568
    v_permlane32_swap_b32 v64, v66
    v_permlane32_swap_b32 v65, v67
    v_pk_add_f32 v[64:65], v[64:65], v[66:67]
    v_lshl_add_u32 v13, v13, 4, s28
    s_nop 0
    v_permlane16_swap_b32 v64, v65
    v_add_f32 v64, v64, v65
    s_nop 1
    v_add_f32_dpp v64, v64, v64 row_ror:4 row_mask:0xf bank_mask:0xf
    s_nop 1
    v_add_f32_dpp v64, v64, v64 row_ror:8 row_mask:0xf bank_mask:0xf
    s_mov_b64 exec, s[80:81]
    ds_write2_b32 v13, v68, v64 offset0:0 offset1:16
    s_mov_b64 exec, -1
    s_waitcnt lgkmcnt(0)
    buffer_load_dwordx4 v[76:79], v1, s[16:19], s33 offen sc1
L_q_join:
    v_mov_b32 v74, s51
    v_mov_b32 v14, 0xffbfffbf
    s_waitcnt lgkmcnt(0)
    s_barrier
    ds_read_b128 v[56:59], v74
    ds_read_b128 v[60:63], v74 offset:64
    buffer_load_dwordx4 v[76:79], v1, s[16:19], s33 offen sc1
    v_mov_b64 v[40:41], 0
    v_mov_b64 v[42:43], 0
    v_mov_b64 v[44:45], 0
    v_mov_b64 v[46:47], 0
    v_mov_b64 v[48:49], 0
    v_mov_b64 v[50:51], 0
    v_mov_b64 v[52:53], 0
    v_mov_b64 v[54:55], 0
    s_mov_b32 s7, 1
    s_waitcnt lgkmcnt(0)
    v_pk_add_f32 v[56:57], v[56:57], v[58:59]
    v_pk_add_f32 v[60:61], v[60:61], v[62:63]
    v_add_f32 v56, v56, v57
    v_add_f32 v60, v60, v61
    v_mul_f32 v57, 0x3c7af233, v56
    v_mul_f32 v60, 0x3df5fdf0, v60
    v_fma_f32 v60, -v57, v57, v60
    v_max_f32 v60, 0, v60
    v_add_f32 v60, 0x3a21369a, v60
    v_rsq_f32 v10, v60
    s_waitcnt vmcnt(1)
L_q2_c:
    v_max3_u32 v13, v76, v77, v78
    v_max_u32 v13, v13, v79
    v_cmp_eq_u32 vcc, 0xffbfffbf, v13
    s_cbranch_vccnz L_q2_2
L_q2_g:
    v_mov_b32_dpp v60, v76 row_shl:8 row_mask:0xf bank_mask:0xf bound_ctrl:0
    v_mov_b32_dpp v61, v77 row_shl:8 row_mask:0xf bank_mask:0xf bound_ctrl:0
    v_mov_b32_dpp v62, v78 row_shl:8 row_mask:0xf bank_mask:0xf bound_ctrl:0
    v_mov_b32_dpp v63, v79 row_shl:8 row_mask:0xf bank_mask:0xf bound_ctrl:0
    v_mov_b32_dpp v64, v76 row_shr:8 row_mask:0xf bank_mask:0xf bound_ctrl:0
    v_mov_b32_dpp v65, v77 row_shr:8 row_mask:0xf bank_mask:0xf bound_ctrl:0
    v_smfmac_f32_16x16x64_bf16 v[24:27], v[60:63], a[8:15], v15
    ds_read_b64_tr_b16 a[8:9], v3 offset:0
    v_mov_b32_dpp v66, v78 row_shr:8 row_mask:0xf bank_mask:0xf bound_ctrl:0
    v_smfmac_f32_16x16x64_bf16 v[28:31], v[60:63], a[24:31], v15
    ds_read_b64_tr_b16 a[10:11], v3 offset:4096
    v_mov_b32_dpp v67, v79 row_shr:8 row_mask:0xf bank_mask:0xf bound_ctrl:0
    v_smfmac_f32_16x16x64_bf16 v[32:35], v[60:63], a[40:47], v15
    ds_read_b64_tr_b16 a[12:13], v3 offset:8192
    v_mov_b32_dpp v68, v60 row_ror:8 row_mask:0xf bank_mask:0xf
    v_smfmac_f32_16x16x64_bf16 v[36:39], v[60:63], a[56:63], v15
    ds_read_b64_tr_b16 a[14:15], v3 offset:12288
    v_mov_b32_dpp v69, v61 row_ror:8 row_mask:0xf bank_mask:0xf
    v_smfmac_f32_16x16x64_bf16 v[24:27], v[64:67], a[64:71], v15
    ds_read_b64_tr_b16 a[24:25], v5 offset:0
    v_mov_b32_dpp v70, v62 row_ror:8 row_mask:0xf bank_mask:0xf
    v_smfmac_f32_16x16x64_bf16 v[28:31], v[64:67], a[80:87], v15
    ds_read_b64_tr_b16 a[26:27], v5 offset:4096
    v_mov_b32_dpp v71, v63 row_ror:8 row_mask:0xf bank_mask:0xf
    v_smfmac_f32_16x16x64_bf16 v[32:35], v[64:67], a[96:103], v15
    ds_read_b64_tr_b16 a[28:29], v5 offset:8192
    v_mov_b32_dpp v56, v64 row_ror:8 row_mask:0xf bank_mask:0xf
    v_smfmac_f32_16x16x64_bf16 v[36:39], v[64:67], a[112:119], v15
    ds_read_b64_tr_b16 a[30:31], v5 offset:12288
    v_mov_b32_dpp v57, v65 row_ror:8 row_mask:0xf bank_mask:0xf
    v_smfmac_f32_16x16x64_bf16 v[24:27], v[68:71], a[72:79], v15
    ds_read_b64_tr_b16 a[64:65], v2 offset:16384
    v_mov_b32_dpp v58, v66 row_ror:8 row_mask:0xf bank_mask:0xf
    v_smfmac_f32_16x16x64_bf16 v[28:31], v[68:71], a[88:95], v15
    ds_read_b64_tr_b16 a[66:67], v2 offset:20480
    v_mov_b32_dpp v59, v67 row_ror:8 row_mask:0xf bank_mask:0xf
    v_smfmac_f32_16x16x64_bf16 v[32:35], v[68:71], a[104:111], v15
    ds_read_b64_tr_b16 a[68:69], v2 offset:24576
    v_mov_b32_dpp v74, v75 row_ror:8 row_mask:0xf bank_mask:0xf
    v_smfmac_f32_16x16x64_bf16 v[36:39], v[68:71], a[120:127], v15
    ds_read_b64_tr_b16 a[70:71], v2 offset:28672
    v_mov_b64 v[20:21], 0
    v_smfmac_f32_16x16x64_bf16 v[24:27], v[56:59], a[0:7], v15
    ds_read_b64_tr_b16 a[72:73], v3 offset:16384
    v_mov_b64 v[22:23], 0
    v_smfmac_f32_16x16x64_bf16 v[28:31], v[56:59], a[16:23], v15
    ds_read_b64_tr_b16 a[74:75], v3 offset:20480
    s_waitcnt vmcnt(0)
    v_mov_b64 v[76:77], 0
    v_smfmac_f32_16x16x64_bf16 v[32:35], v[56:59], a[32:39], v15
    ds_read_b64_tr_b16 a[76:77], v3 offset:24576
    v_mov_b64 v[78:79], 0
    v_smfmac_f32_16x16x64_bf16 v[36:39], v[56:59], a[48:55], v15
    ds_read_b64_tr_b16 a[78:79], v3 offset:28672
    v_add_f32 v24, v24, v26
    v_smfmac_f32_16x16x64_bf16 v[40:43], v[56:59], a[128:135], v15
    ds_read_b64_tr_b16 a[0:1], v2 offset:0
    buffer_store_dword v14, v18, s[16:19], s93 offen
    v_add_f32 v25, v25, v27
    v_smfmac_f32_16x16x64_bf16 v[40:43], v[60:63], a[136:143], v15
    ds_read_b64_tr_b16 a[2:3], v2 offset:4096
    v_add_f32 v26, v28, v30
    v_smfmac_f32_16x16x64_bf16 v[40:43], v[64:67], a[192:199], v15
    ds_read_b64_tr_b16 a[4:5], v2 offset:8192
    v_add_f32 v27, v29, v31
    v_smfmac_f32_16x16x64_bf16 v[40:43], v[68:71], a[200:207], v15
    ds_read_b64_tr_b16 a[6:7], v2 offset:12288
    v_add_f32 v32, v32, v34
    v_smfmac_f32_16x16x64_bf16 v[44:47], v[56:59], a[144:151], v15
    ds_read_b64_tr_b16 a[16:17], v4 offset:0
    buffer_store_dword v14, v18, s[16:19], s94 offen sc1
    v_add_f32 v33, v33, v35
    v_smfmac_f32_16x16x64_bf16 v[44:47], v[60:63], a[152:159], v15
    ds_read_b64_tr_b16 a[18:19], v4 offset:4096
    v_add_f32 v34, v36, v38
    v_smfmac_f32_16x16x64_bf16 v[44:47], v[64:67], a[208:215], v15
    ds_read_b64_tr_b16 a[20:21], v4 offset:8192
L_pad9:
    s_cbranch_execz L_ret
    v_add_f32 v35, v37, v39
    v_smfmac_f32_16x16x64_bf16 v[44:47], v[68:71], a[216:223], v15
    ds_read_b64_tr_b16 a[22:23], v4 offset:12288
    v_max_f32 v72, v24, v26
    v_smfmac_f32_16x16x64_bf16 v[48:51], v[56:59], a[160:167], v15
    ds_read_b64_tr_b16 a[80:81], v4 offset:16384
    v_max_f32 v73, v25, v27
    v_smfmac_f32_16x16x64_bf16 v[48:51], v[60:63], a[168:175], v15
    ds_read_b64_tr_b16 a[82:83], v4 offset:20480
    v_add_f32 v40, v40, v42
    v_smfmac_f32_16x16x64_bf16 v[48:51], v[64:67], a[224:231], v15
    ds_read_b64_tr_b16 a[84:85], v4 offset:24576
    v_add_f32 v41, v41, v43
    v_smfmac_f32_16x16x64_bf16 v[48:51], v[68:71], a[232:239], v15
    ds_read_b64_tr_b16 a[86:87], v4 offset:28672
    v_max3_f32 v72, v72, v32, v34
    v_smfmac_f32_16x16x64_bf16 v[52:55], v[56:59], a[176:183], v15
    ds_read_b64_tr_b16 a[88:89], v5 offset:16384
    v_max3_f32 v73, v73, v33, v35
    v_smfmac_f32_16x16x64_bf16 v[52:55], v[60:63], a[184:191], v15
    ds_read_b64_tr_b16 a[90:91], v5 offset:20480
    v_add_f32 v42, v44, v46
    v_smfmac_f32_16x16x64_bf16 v[52:55], v[64:67], a[240:247], v15
    ds_read_b64_tr_b16 a[92:93], v5 offset:24576
    v_add_f32 v43, v45, v47
    v_smfmac_f32_16x16x64_bf16 v[52:55], v[68:71], a[248:255], v15
    ds_read_b64_tr_b16 a[94:95], v5 offset:28672
    ds_read_b64_tr_b16 a[32:33], v6 offset:0
    ds_read_b64_tr_b16 a[34:35], v6 offset:4096
    ds_read_b64_tr_b16 a[36:37], v6 offset:8192
    v_max3_f32 v72, v72, v40, v42
    v_max3_f32 v73, v73, v41, v43
    v_add_f32 v48, v48, v50
    v_add_f32 v49, v49, v51
    v_pk_add_f32 v[50:51], v[52:53], v[54:55]
    v_max3_f32 v72, v72, v48, v50
    v_max3_f32 v73, v73, v49, v51
    v_mov_b64 v[28:29], 0
    v_mov_b64 v[30:31], 0
    v_permlane32_swap_b32 v72, v73
    v_max_f32 v14, v72, v73
    v_mov_b64 v[36:37], 0
    v_mov_b64 v[38:39], 0
    v_max_f32_dpp v14, v14, v14 row_ror:1 row_mask:0xf bank_mask:0xf
    ds_read_b64_tr_b16 a[38:39], v6 offset:12288
    ds_read_b64_tr_b16 a[40:41], v7 offset:0
    v_max_f32_dpp v14, v14, v14 row_ror:2 row_mask:0xf bank_mask:0xf
    ds_read_b64_tr_b16 a[42:43], v7 offset:4096
    ds_read_b64_tr_b16 a[44:45], v7 offset:8192
    v_max_f32_dpp v14, v14, v14 row_ror:4 row_mask:0xf bank_mask:0xf
    ds_read_b64_tr_b16 a[46:47], v7 offset:12288
    ds_read_b64_tr_b16 a[96:97], v6 offset:16384
    v_max_f32_dpp v14, v14, v14 row_ror:8 row_mask:0xf bank_mask:0xf
    v_mul_f32 v72, v14, v10
    v_mul_f32 v73, v14, v10
    v_mul_f32 v14, v14, v10
    s_nop 0
    v_permlane32_swap_b32 v72, v73
    v_pk_fma_f32 v[24:25], v[24:25], v[10:11], v[72:73] op_sel_hi:[1,0,1] neg_lo:[0,0,1] neg_hi:[0,0,1]
    v_pk_fma_f32 v[26:27], v[26:27], v[10:11], v[72:73] op_sel_hi:[1,0,1] neg_lo:[0,0,1] neg_hi:[0,0,1]
    v_pk_fma_f32 v[32:33], v[32:33], v[10:11], v[72:73] op_sel_hi:[1,0,1] neg_lo:[0,0,1] neg_hi:[0,0,1]
    v_pk_fma_f32 v[34:35], v[34:35], v[10:11], v[72:73] op_sel_hi:[1,0,1] neg_lo:[0,0,1] neg_hi:[0,0,1]
    v_exp_f32 v24, v24
    v_exp_f32 v26, v26
    v_exp_f32 v32, v32
    v_exp_f32 v34, v34
    v_cvt_pk_bf16_f32 v44, v24, v26
    v_cvt_pk_bf16_f32 v45, v32, v34
    ds_write_b64 v12, v[44:45] offset:0
    v_exp_f32 v25, v25
    v_exp_f32 v27, v27
    v_exp_f32 v33, v33
    v_exp_f32 v35, v35
    v_cvt_pk_bf16_f32 v46, v25, v27
    v_cvt_pk_bf16_f32 v47, v33, v35
    ds_write_b64 v12, v[46:47] offset:16
    ds_read_b128 v[56:59], v75 offset:0
    v_pk_fma_f32 v[40:41], v[40:41], v[10:11], v[72:73] op_sel_hi:[1,0,1] neg_lo:[0,0,1] neg_hi:[0,0,1]
    v_pk_fma_f32 v[42:43], v[42:43], v[10:11], v[72:73] op_sel_hi:[1,0,1] neg_lo:[0,0,1] neg_hi:[0,0,1]
    v_pk_fma_f32 v[48:49], v[48:49], v[10:11], v[72:73] op_sel_hi:[1,0,1] neg_lo:[0,0,1] neg_hi:[0,0,1]
    v_pk_fma_f32 v[50:51], v[50:51], v[10:11], v[72:73] op_sel_hi:[1,0,1] neg_lo:[0,0,1] neg_hi:[0,0,1]
    ds_read_b128 v[64:67], v74 offset:0
    ds_read_b64_tr_b16 a[98:99], v6 offset:20480
    ds_read_b64_tr_b16 a[100:101], v6 offset:24576
    ds_read_b64_tr_b16 a[102:103], v6 offset:28672
    ds_read_b64_tr_b16 a[104:105], v7 offset:16384
    ds_read_b64_tr_b16 a[106:107], v7 offset:20480
    ds_read_b64_tr_b16 a[108:109], v7 offset:24576
    v_exp_f32 v40, v40
    v_exp_f32 v42, v42
    v_exp_f32 v48, v48
    v_exp_f32 v50, v50
    v_cvt_pk_bf16_f32 v52, v40, v42
    v_cvt_pk_bf16_f32 v53, v48, v50
    ds_write_b64 v12, v[52:53] offset:1152
    v_exp_f32 v41, v41
    v_exp_f32 v43, v43
    v_exp_f32 v49, v49
    v_exp_f32 v51, v51
    v_cvt_pk_bf16_f32 v54, v41, v43
    v_cvt_pk_bf16_f32 v55, v49, v51
    ds_write_b64 v12, v[54:55] offset:1168
    v_pk_add_f32 v[24:25], v[24:25], v[26:27]
    v_pk_add_f32 v[24:25], v[24:25], v[32:33]
    v_pk_add_f32 v[24:25], v[24:25], v[34:35]
    v_pk_add_f32 v[24:25], v[24:25], v[40:41]
    v_pk_add_f32 v[24:25], v[24:25], v[42:43]
    s_waitcnt lgkmcnt(9)
    v_smfmac_f32_16x16x64_bf16 v[20:23], v[56:59], v[128:135], v15
    ds_read_b128 v[60:63], v75 offset:576
    v_add_f32 v24, v24, v48
    v_smfmac_f32_16x16x64_bf16 v[76:79], v[56:59], v[144:151], v15
    ds_read_b128 v[68:71], v74 offset:576
    v_add_f32 v25, v25, v49
    v_smfmac_f32_16x16x64_bf16 v[28:31], v[56:59], v[160:167], v15
    ds_read_b64_tr_b16 a[110:111], v7 offset:28672
    v_add_f32 v24, v24, v50
    v_smfmac_f32_16x16x64_bf16 v[36:39], v[56:59], v[176:183], v15
    ds_read_b64_tr_b16 a[48:49], v8 offset:0
    v_add_f32 v25, v25, v51
    s_waitcnt lgkmcnt(12)
    v_smfmac_f32_16x16x64_bf16 v[20:23], v[64:67], v[136:143], v15
    ds_read_b128 v[56:59], v75 offset:1152
    v_mov_b32 v72, v14
    v_smfmac_f32_16x16x64_bf16 v[76:79], v[64:67], v[152:159], v15
    ds_read_b64_tr_b16 a[50:51], v8 offset:4096
    v_permlane32_swap_b32 v24, v25
    v_smfmac_f32_16x16x64_bf16 v[28:31], v[64:67], v[168:175], v15
    ds_read_b64_tr_b16 a[52:53], v8 offset:8192
    v_add_f32 v73, v24, v25
    v_smfmac_f32_16x16x64_bf16 v[36:39], v[64:67], v[184:191], v15
    ds_read_b64_tr_b16 a[54:55], v8 offset:12288
    v_add_f32_dpp v73, v73, v73 row_ror:1 row_mask:0xf bank_mask:0xf
    s_waitcnt lgkmcnt(7)
    v_smfmac_f32_16x16x64_bf16 v[20:23], v[60:63], v[192:199], v15
    ds_read_b128 v[64:67], v74 offset:1152
    v_add_f32_dpp v73, v73, v73 row_ror:2 row_mask:0xf bank_mask:0xf
    v_smfmac_f32_16x16x64_bf16 v[76:79], v[60:63], v[208:215], v15
    ds_read_b64_tr_b16 a[56:57], v9 offset:0
    v_add_f32_dpp v73, v73, v73 row_ror:4 row_mask:0xf bank_mask:0xf
    v_smfmac_f32_16x16x64_bf16 v[28:31], v[60:63], v[224:231], v15
    ds_read_b64_tr_b16 a[58:59], v9 offset:4096
    v_add_f32_dpp v73, v73, v73 row_ror:8 row_mask:0xf bank_mask:0xf
    v_smfmac_f32_16x16x64_bf16 v[36:39], v[60:63], v[240:247], v15
    ds_write_b64 v19, v[72:73]
    v_mov_b32 v12, s50
    s_waitcnt lgkmcnt(10)
    v_smfmac_f32_16x16x64_bf16 v[20:23], v[68:71], v[200:207], v15
    ds_read_b128 v[60:63], v75 offset:1728
    v_smfmac_f32_16x16x64_bf16 v[76:79], v[68:71], v[216:223], v15
    ds_read_b64_tr_b16 a[60:61], v9 offset:8192
L_pad10:
    s_cbranch_execz L_ret
    v_smfmac_f32_16x16x64_bf16 v[28:31], v[68:71], v[232:239], v15
    ds_read_b64_tr_b16 a[62:63], v9 offset:12288
    v_smfmac_f32_16x16x64_bf16 v[36:39], v[68:71], v[248:255], v15
    ds_read_b128 v[68:71], v74 offset:1728
    s_waitcnt lgkmcnt(4)
    s_barrier
    v_smfmac_f32_16x16x64_bf16 v[20:23], v[56:59], a[0:7], v15
    ds_read_b128 v[40:43], v12
    v_smfmac_f32_16x16x64_bf16 v[20:23], v[64:67], a[8:15], v15
    ds_read_b128 v[44:47], v12 offset:16
    s_waitcnt lgkmcnt(5)
    v_smfmac_f32_16x16x64_bf16 v[20:23], v[60:63], a[64:71], v15
    ds_read_b64_tr_b16 a[112:113], v8 offset:16384
    s_waitcnt lgkmcnt(3)
    v_smfmac_f32_16x16x64_bf16 v[20:23], v[68:71], a[72:79], v15
    ds_read_b64_tr_b16 a[114:115], v8 offset:20480
    v_smfmac_f32_16x16x64_bf16 v[76:79], v[56:59], a[16:23], v15
    ds_read_b64_tr_b16 a[116:117], v8 offset:24576
    v_smfmac_f32_16x16x64_bf16 v[76:79], v[64:67], a[24:31], v15
    ds_read_b64_tr_b16 a[118:119], v8 offset:28672
    s_waitcnt lgkmcnt(4)
    v_max3_f32 v14, v40, v42, v44
    v_smfmac_f32_16x16x64_bf16 v[76:79], v[60:63], a[80:87], v15
    ds_read_b64_tr_b16 a[120:121], v9 offset:16384
    v_add_f32 v20, v20, v22
    v_smfmac_f32_16x16x64_bf16 v[76:79], v[68:71], a[88:95], v15
    ds_read_b64_tr_b16 a[122:123], v9 offset:20480
    v_add_f32 v21, v21, v23
    v_smfmac_f32_16x16x64_bf16 v[28:31], v[56:59], a[32:39], v15
    ds_write2_b32 v16, v20, v21 offset0:0 offset1:132
    v_max_f32 v14, v14, v46
    v_smfmac_f32_16x16x64_bf16 v[28:31], v[64:67], a[40:47], v15
    ds_read_b64_tr_b16 a[124:125], v9 offset:24576
    v_sub_f32 v40, v40, v14
    v_smfmac_f32_16x16x64_bf16 v[28:31], v[60:63], a[96:103], v15
    ds_read_b64_tr_b16 a[126:127], v9 offset:28672
    v_add_f32 v76, v76, v78
    v_smfmac_f32_16x16x64_bf16 v[28:31], v[68:71], a[104:111], v15
    v_add_f32 v77, v77, v79
    v_smfmac_f32_16x16x64_bf16 v[36:39], v[56:59], a[48:55], v15
    ds_write2_b32 v16, v76, v77 offset0:32 offset1:164
    v_sub_f32 v42, v42, v14
    v_smfmac_f32_16x16x64_bf16 v[36:39], v[64:67], a[56:63], v15
    v_sub_f32 v44, v44, v14
    s_waitcnt lgkmcnt(6)
    v_smfmac_f32_16x16x64_bf16 v[36:39], v[60:63], a[112:119], v15
    v_add_f32 v28, v28, v30
    s_waitcnt lgkmcnt(1)
    v_smfmac_f32_16x16x64_bf16 v[36:39], v[68:71], a[120:127], v15
    v_add_f32 v29, v29, v31
    ds_write2_b32 v16, v28, v29 offset0:64 offset1:196
    v_sub_f32 v46, v46, v14
    v_exp_f32 v20, v40
    v_exp_f32 v21, v42
    v_exp_f32 v22, v44
    v_exp_f32 v23, v46
    s_nop 0
    v_pk_add_f32 v[36:37], v[36:37], v[38:39]
    ds_write2_b32 v16, v36, v37 offset0:96 offset1:228
    v_mul_f32 v15, v20, v41
    v_fmac_f32 v15, v21, v43
    v_fmac_f32 v15, v22, v45
    v_fmac_f32 v15, v23, v47
    s_branch L_comb2
L_final:
    s_nop 2
    v_add_f32_dpp v60, v64, v60 row_ror:12 row_mask:0xf bank_mask:0xf
    v_add_f32_dpp v61, v65, v61 row_ror:12 row_mask:0xf bank_mask:0xf
    v_add_f32_dpp v62, v66, v62 row_ror:12 row_mask:0xf bank_mask:0xf
    v_add_f32_dpp v63, v67, v63 row_ror:12 row_mask:0xf bank_mask:0xf
    v_add_f32_dpp v60, v72, v60 row_ror:4 row_mask:0xf bank_mask:0xf
    v_add_f32_dpp v61, v73, v61 row_ror:4 row_mask:0xf bank_mask:0xf
    v_add_f32_dpp v62, v74, v62 row_ror:4 row_mask:0xf bank_mask:0xf
    v_add_f32_dpp v63, v75, v63 row_ror:4 row_mask:0xf bank_mask:0xf
    v_add_f32_dpp v60, v68, v60 row_ror:8 row_mask:0xf bank_mask:0xf
    v_add_f32_dpp v61, v69, v61 row_ror:8 row_mask:0xf bank_mask:0xf
    v_add_f32_dpp v62, v70, v62 row_ror:8 row_mask:0xf bank_mask:0xf
    v_add_f32_dpp v63, v71, v63 row_ror:8 row_mask:0xf bank_mask:0xf
    s_mov_b64 exec, s[78:79]
    v_pk_fma_f32 v[76:77], v[60:61], v[12:13], v[76:77] op_sel_hi:[1,0,1]
    v_pk_fma_f32 v[78:79], v[62:63], v[12:13], v[78:79] op_sel_hi:[1,0,1]
    buffer_store_dwordx4 v[76:79], v10, s[16:19], s75 offen sc1
    s_mov_b64 exec, -1
    s_lshr_b32 s28, s5, 2
    s_cmp_lg_u32 s28, s4
    s_cbranch_scc1 L_exit
    s_mov_b32 s20, s54
    s_and_b32 s21, s55, 0xffff
    s_mov_b32 s22, 4096
    s_mov_b32 s23, 0x20000
    v_and_b32 v14, 0xc0, v1
    v_lshlrev_b32 v14, 4, v14
    v_and_b32 v15, 0x30, v1
    v_lshrrev_b32 v15, 1, v15
    v_add_u32 v14, v14, v15
    s_lshl_b32 s28, s5, 5
    s_waitcnt vmcnt(0)
    buffer_load_dwordx4 v[52:55], v1, s[16:19], s76 offen sc1
    buffer_load_dwordx4 v[56:59], v1, s[16:19], s76 offen offset:1024 sc1
    s_waitcnt vmcnt(0)
L_z_c:
L_z_s:
    v_pk_add_f32 v[60:61], v[52:53], v[56:57]
    v_max3_u32 v13, v52, v53, v54
    v_pk_add_f32 v[62:63], v[54:55], v[58:59]
    v_max3_u32 v13, v13, v55, v56
    s_nop 0
    v_permlane32_swap_b32 v60, v62
    v_max3_u32 v13, v13, v57, v58
    v_permlane32_swap_b32 v61, v63
    v_max_u32 v13, v13, v59
    v_pk_add_f32 v[60:61], v[60:61], v[62:63]
    v_cmp_eq_u32 vcc, 0xffbfffbf, v13
    s_nop 0
    v_permlane16_swap_b32 v60, v61
    v_add_f32 v60, v60, v61
    s_cbranch_vccnz L_z_l
L_z_g:
    v_mov_b32 v61, v60
    s_nop 1
    v_permlane16_swap_b32 v60, v61
    v_cvt_pk_bf16_f32 v62, v60, v61
    v_cvt_pk_bf16_f32 v63, v60, v61
    s_nop 1
    v_permlane32_swap_b32 v62, v63
    s_mov_b64 exec, 0xffff
    buffer_store_dwordx2 v[62:63], v14, s[20:23], s28 offen
    s_mov_b64 exec, -1
L_exit:
L_end:
    s_endpgm
L_cnt_x:
    s_mov_b32 s27, 0
    s_waitcnt lgkmcnt(0)
    s_branch L_cnt_g
L_init_r:
    s_cmp_eq_u32 s27, 0
    s_cbranch_scc1 L_init_g
    s_sub_u32 s27, s27, 1
    global_load_dwordx2 v[60:61], v63, s[56:57] sc1
    s_waitcnt vmcnt(0)
    s_branch L_init_w
L_slow59:
    buffer_store_dword v40, v41, s[16:19], s28 offen sc1
    s_branch L_slow59b
L_q1_r:
    s_cmp_eq_u32 s27, 0
    s_cbranch_scc1 L_q1_g
    s_sub_u32 s27, s27, 1
    buffer_load_dwordx4 v[32:35], v1, s[16:19], s33 offen sc1
    s_waitcnt vmcnt(0)
    s_branch L_q1_w
L_slow110:
    s_waitcnt vmcnt(0) lgkmcnt(0)
    s_barrier
    ds_read_b64 v[64:65], v17 offset:0
    ds_read_b64 v[66:67], v17 offset:4224
    ds_read_b64 v[68:69], v17 offset:8448
    ds_read_b64 v[70:71], v17 offset:12672
    s_mov_b64 exec, 1
    buffer_store_dwordx2 v[14:15], v1, s[16:19], s61 offen sc1
    s_mov_b64 exec, -1
    s_waitcnt lgkmcnt(3)
    v_pk_mul_f32 v[64:65], v[64:65], v[20:21] op_sel:[0,0] op_sel_hi:[1,0]
    s_waitcnt lgkmcnt(2)
    v_pk_fma_f32 v[64:65], v[66:67], v[20:21], v[64:65] op_sel:[0,1,0] op_sel_hi:[1,1,1]
    s_waitcnt lgkmcnt(1)
    v_pk_fma_f32 v[64:65], v[68:69], v[22:23], v[64:65] op_sel:[0,0,0] op_sel_hi:[1,0,1]
    s_waitcnt lgkmcnt(0)
    v_pk_fma_f32 v[64:65], v[70:71], v[22:23], v[64:65] op_sel:[0,1,0] op_sel_hi:[1,1,1]
    v_cvt_pk_bf16_f32 v64, v64, v65
    buffer_load_dwordx2 v[76:77], v11, s[16:19], s64 offen sc1
    buffer_store_dword v64, v18, s[16:19], s60 offen sc1
    s_branch L_slow110b
L_os_l:
    buffer_load_dwordx2 v[76:77], v11, s[16:19], s64 offen sc1
    s_sub_u32 s27, s27, 1
    s_cbranch_scc1 L_os_x
    s_waitcnt vmcnt(4)
    v_max_u32 v13, v76, v77
    v_cmp_eq_u32 vcc, 0xffbfffbf, v13
    s_cbranch_vccnz L_os_l
L_pad11:
    s_cbranch_execz L_ret
    s_branch L_os_g
L_os_x:
    s_mov_b32 s27, 0
    s_branch L_os_g
L_o_r0:
    buffer_load_dwordx4 v[24:27], v1, s[16:19], s62 offen offset:0 sc1
    buffer_load_dwordx4 v[28:31], v1, s[16:19], s62 offen offset:1024 sc1
    s_bitset1_b32 s90, 0
    s_branch L_o_n0
L_o_r1:
    buffer_load_dwordx4 v[32:35], v1, s[16:19], s62 offen offset:2048 sc1
    buffer_load_dwordx4 v[36:39], v1, s[16:19], s62 offen offset:3072 sc1
    s_bitset1_b32 s90, 1
    s_branch L_o_n1
L_o_r2:
    buffer_load_dwordx4 v[40:43], v1, s[16:19], s63 offen offset:0 sc1
    buffer_load_dwordx4 v[44:47], v1, s[16:19], s63 offen offset:1024 sc1
    s_bitset1_b32 s90, 2
    s_branch L_o_n2
L_o_enter:
    s_bitset1_b32 s90, 3
L_o_slow:
    s_cmp_eq_u32 s27, 0
    s_cbranch_scc1 L_o_out
    s_sub_u32 s27, s27, 1
    s_waitcnt vmcnt(0)
    s_bitcmp1_b32 s90, 0
    s_cbranch_scc0 L_o_s0
    v_max3_u32 v13, v24, v25, v26
    v_max3_u32 v13, v13, v27, v28
    v_max3_u32 v13, v13, v29, v30
    v_max_u32 v13, v13, v31
    v_cmp_eq_u32 vcc, 0xffbfffbf, v13
    s_cbranch_vccz L_o_v0
    buffer_load_dwordx4 v[24:27], v1, s[16:19], s62 offen offset:0 sc1
    buffer_load_dwordx4 v[28:31], v1, s[16:19], s62 offen offset:1024 sc1
    s_branch L_o_s0
L_o_v0:
    s_bitset0_b32 s90, 0
    v_mfma_f32_16x16x32_bf16 v[56:59], v[24:27], v[96:99], v[56:59]
    v_mfma_f32_16x16x32_bf16 v[60:63], v[28:31], v[96:99], v[60:63]
L_o_s0:
    s_bitcmp1_b32 s90, 1
    s_cbranch_scc0 L_o_s1
    v_max3_u32 v13, v32, v33, v34
    v_max3_u32 v13, v13, v35, v36
    v_max3_u32 v13, v13, v37, v38
    v_max_u32 v13, v13, v39
    v_cmp_eq_u32 vcc, 0xffbfffbf, v13
    s_cbranch_vccz L_o_v1
    buffer_load_dwordx4 v[32:35], v1, s[16:19], s62 offen offset:2048 sc1
    buffer_load_dwordx4 v[36:39], v1, s[16:19], s62 offen offset:3072 sc1
    s_branch L_o_s1
L_o_v1:
    s_bitset0_b32 s90, 1
    v_mfma_f32_16x16x32_bf16 v[56:59], v[32:35], v[100:103], v[56:59]
    v_mfma_f32_16x16x32_bf16 v[60:63], v[36:39], v[100:103], v[60:63]
L_o_s1:
    s_bitcmp1_b32 s90, 2
    s_cbranch_scc0 L_o_s2
    v_max3_u32 v13, v40, v41, v42
    v_max3_u32 v13, v13, v43, v44
    v_max3_u32 v13, v13, v45, v46
    v_max_u32 v13, v13, v47
    v_cmp_eq_u32 vcc, 0xffbfffbf, v13
    s_cbranch_vccz L_o_v2
    buffer_load_dwordx4 v[40:43], v1, s[16:19], s63 offen offset:0 sc1
    buffer_load_dwordx4 v[44:47], v1, s[16:19], s63 offen offset:1024 sc1
    s_branch L_o_s2
L_o_v2:
    s_bitset0_b32 s90, 2
    v_mfma_f32_16x16x32_bf16 v[56:59], v[40:43], v[104:107], v[56:59]
    v_mfma_f32_16x16x32_bf16 v[60:63], v[44:47], v[104:107], v[60:63]
L_o_s2:
    s_bitcmp1_b32 s90, 3
    s_cbranch_scc0 L_o_s3
    v_max3_u32 v13, v48, v49, v50
    v_max3_u32 v13, v13, v51, v52
    v_max3_u32 v13, v13, v53, v54
    v_max_u32 v13, v13, v55
    v_cmp_eq_u32 vcc, 0xffbfffbf, v13
    s_cbranch_vccz L_o_v3
    buffer_load_dwordx4 v[48:51], v1, s[16:19], s63 offen offset:2048 sc1
    buffer_load_dwordx4 v[52:55], v1, s[16:19], s63 offen offset:3072 sc1
    s_branch L_o_s3
L_o_v3:
    s_bitset0_b32 s90, 3
    v_mfma_f32_16x16x32_bf16 v[56:59], v[48:51], v[108:111], v[56:59]
    v_mfma_f32_16x16x32_bf16 v[60:63], v[52:55], v[108:111], v[60:63]
L_o_s3:
    s_cmp_lg_u32 s90, 0
    s_cbranch_scc1 L_o_slow
L_o_out:
    s_nop 7
    v_mov_b32 v64, v56
    v_mov_b32 v65, v57
    v_mov_b32 v66, v58
    v_mov_b32 v67, v59
    v_mov_b32 v68, v60
    v_mov_b32 v69, v61
    v_mov_b32 v70, v62
    v_mov_b32 v71, v63
    s_nop 1
    s_branch L_o_done
L_o_oth:
    s_waitcnt lgkmcnt(0)
    s_barrier
    s_cmp_lg_u32 s3, 3
    s_cbranch_scc1 L_hy_f
    v_lshlrev_b32 v14, 3, v1
    v_mov_b32 v15, 0xffbfffbf
    s_mov_b64 exec, s[46:47]
    buffer_load_dword v15, v14, s[16:19], s92 offen sc1
    s_mov_b64 exec, -1
L_hy_f:
    s_branch L_o_join
L_hy_x:
    s_mov_b32 s27, 0
    s_branch L_hy_g
L_f_r0:
    buffer_load_dwordx4 v[24:27], v1, s[16:19], s67 offen offset:0 sc1
    buffer_load_dwordx4 v[28:31], v1, s[16:19], s67 offen offset:1024 sc1
    s_bitset1_b32 s90, 0
    s_branch L_f_n0
L_f_r1:
    buffer_load_dwordx4 v[32:35], v1, s[16:19], s67 offen offset:2048 sc1
    buffer_load_dwordx4 v[36:39], v1, s[16:19], s67 offen offset:3072 sc1
    s_bitset1_b32 s90, 1
    s_branch L_f_n1
L_f_r2:
    buffer_load_dwordx4 v[40:43], v1, s[16:19], s68 offen offset:0 sc1
    buffer_load_dwordx4 v[44:47], v1, s[16:19], s68 offen offset:1024 sc1
    s_bitset1_b32 s90, 2
    s_branch L_f_n2
L_f_enter:
    s_bitset1_b32 s90, 3
L_f_slow:
    s_cmp_eq_u32 s27, 0
    s_cbranch_scc1 L_f_out
    s_sub_u32 s27, s27, 1
    s_waitcnt vmcnt(0)
    s_bitcmp1_b32 s90, 0
    s_cbranch_scc0 L_f_s0
    v_max3_u32 v13, v24, v25, v26
    v_max3_u32 v13, v13, v27, v28
    v_max3_u32 v13, v13, v29, v30
    v_max_u32 v13, v13, v31
    v_cmp_eq_u32 vcc, 0xffbfffbf, v13
    s_cbranch_vccz L_f_v0
    buffer_load_dwordx4 v[24:27], v1, s[16:19], s67 offen offset:0 sc1
    buffer_load_dwordx4 v[28:31], v1, s[16:19], s67 offen offset:1024 sc1
    s_branch L_f_s0
L_f_v0:
    s_bitset0_b32 s90, 0
    v_mfma_f32_16x16x32_bf16 v[60:63], v[24:27], v[20:23], v[60:63]
    v_mfma_f32_16x16x32_bf16 v[56:59], v[24:27], v[112:115], v[56:59]
    v_mfma_f32_16x16x32_bf16 v[64:67], v[24:27], v[24:27], v[64:67]
    v_mfma_f32_16x16x32_bf16 v[60:63], v[28:31], v[20:23], v[60:63]
    v_mfma_f32_16x16x32_bf16 v[56:59], v[28:31], v[116:119], v[56:59]
    v_mfma_f32_16x16x32_bf16 v[64:67], v[28:31], v[28:31], v[64:67]
L_f_s0:
    s_bitcmp1_b32 s90, 1
    s_cbranch_scc0 L_f_s1
    v_max3_u32 v13, v32, v33, v34
    v_max3_u32 v13, v13, v35, v36
    v_max3_u32 v13, v13, v37, v38
    v_max_u32 v13, v13, v39
    v_cmp_eq_u32 vcc, 0xffbfffbf, v13
    s_cbranch_vccz L_f_v1
    buffer_load_dwordx4 v[32:35], v1, s[16:19], s67 offen offset:2048 sc1
    buffer_load_dwordx4 v[36:39], v1, s[16:19], s67 offen offset:3072 sc1
    s_branch L_f_s1
L_f_v1:
    s_bitset0_b32 s90, 1
    v_mfma_f32_16x16x32_bf16 v[60:63], v[32:35], v[20:23], v[60:63]
    v_mfma_f32_16x16x32_bf16 v[56:59], v[32:35], v[120:123], v[56:59]
    v_mfma_f32_16x16x32_bf16 v[64:67], v[32:35], v[32:35], v[64:67]
    v_mfma_f32_16x16x32_bf16 v[60:63], v[36:39], v[20:23], v[60:63]
    v_mfma_f32_16x16x32_bf16 v[56:59], v[36:39], v[124:127], v[56:59]
    v_mfma_f32_16x16x32_bf16 v[64:67], v[36:39], v[36:39], v[64:67]
L_f_s1:
    s_bitcmp1_b32 s90, 2
    s_cbranch_scc0 L_f_s2
    v_max3_u32 v13, v40, v41, v42
    v_max3_u32 v13, v13, v43, v44
    v_max3_u32 v13, v13, v45, v46
    v_max_u32 v13, v13, v47
    v_cmp_eq_u32 vcc, 0xffbfffbf, v13
    s_cbranch_vccz L_f_v2
    buffer_load_dwordx4 v[40:43], v1, s[16:19], s68 offen offset:0 sc1
    buffer_load_dwordx4 v[44:47], v1, s[16:19], s68 offen offset:1024 sc1
    s_branch L_f_s2
L_f_v2:
    s_bitset0_b32 s90, 2
    v_mfma_f32_16x16x32_bf16 v[60:63], v[40:43], v[20:23], v[60:63]
    v_mfma_f32_16x16x32_bf16 v[56:59], v[40:43], v[112:115], v[56:59]
    v_mfma_f32_16x16x32_bf16 v[60:63], v[44:47], v[20:23], v[60:63]
    v_mfma_f32_16x16x32_bf16 v[56:59], v[44:47], v[116:119], v[56:59]
L_f_s2:
    s_bitcmp1_b32 s90, 3
    s_cbranch_scc0 L_f_s3
    v_max3_u32 v13, v48, v49, v50
    v_max3_u32 v13, v13, v51, v52
L_pad12:
    s_cbranch_execz L_ret
    v_max3_u32 v13, v13, v53, v54
    v_max_u32 v13, v13, v55
    v_cmp_eq_u32 vcc, 0xffbfffbf, v13
    s_cbranch_vccz L_f_v3
    buffer_load_dwordx4 v[48:51], v1, s[16:19], s68 offen offset:2048 sc1
    buffer_load_dwordx4 v[52:55], v1, s[16:19], s68 offen offset:3072 sc1
    s_branch L_f_s3
L_f_v3:
    s_bitset0_b32 s90, 3
    v_mfma_f32_16x16x32_bf16 v[60:63], v[48:51], v[20:23], v[60:63]
    v_mfma_f32_16x16x32_bf16 v[56:59], v[48:51], v[120:123], v[56:59]
    v_mfma_f32_16x16x32_bf16 v[60:63], v[52:55], v[20:23], v[60:63]
    v_mfma_f32_16x16x32_bf16 v[56:59], v[52:55], v[124:127], v[56:59]
L_f_s3:
    s_cmp_lg_u32 s90, 0
    s_cbranch_scc1 L_f_slow
L_f_out:
    s_nop 7
    v_mov_b32 v76, v56
    v_mov_b32 v68, v60
    v_mov_b32 v77, v57
    v_mov_b32 v69, v61
    v_mov_b32 v78, v58
    v_mov_b32 v70, v62
    v_mov_b32 v79, v59
    v_mov_b32 v71, v63
    s_nop 1
    s_branch L_f_done
L_slow111:
    s_waitcnt lgkmcnt(1)
    v_pk_add_f32 v[56:57], v[56:57], v[58:59]
    s_waitcnt lgkmcnt(0)
    v_pk_add_f32 v[76:77], v[76:77], v[78:79]
    v_pk_add_f32 v[56:57], v[56:57], v[76:77]
    s_nop 1
    v_mul_f32_dpp v56, v56, v56 row_half_mirror row_mask:0xf bank_mask:0xf
    v_mul_f32_dpp v57, v57, v57 row_half_mirror row_mask:0xf bank_mask:0xf
    s_mov_b64 exec, 0x0f0f0f0f
    v_cvt_pk_bf16_f32 v58, v56, v57
    buffer_store_dword v58, v74, s[16:19], s71 offen sc1
    s_mov_b64 exec, -1
    s_branch L_slow111b
L_h_2:
    buffer_load_dwordx4 v[52:55], v1, s[16:19], s72 offen sc1
    buffer_load_dwordx4 v[56:59], v1, s[16:19], s72 offen offset:1024 sc1
    s_waitcnt vmcnt(2)
    v_max3_u32 v13, v52, v53, v54
    v_max3_u32 v13, v13, v55, v56
    v_max3_u32 v13, v13, v57, v58
    v_max_u32 v13, v13, v59
    v_cmp_eq_u32 vcc, 0xffbfffbf, v13
    s_cbranch_vccz L_h_g
L_h_l:
    buffer_load_dwordx4 v[52:55], v1, s[16:19], s72 offen sc1
    buffer_load_dwordx4 v[56:59], v1, s[16:19], s72 offen offset:1024 sc1
    s_sub_u32 s27, s27, 1
    s_cbranch_scc1 L_h_x
    s_waitcnt vmcnt(2)
    v_max3_u32 v13, v52, v53, v54
    v_max3_u32 v13, v13, v55, v56
    v_max3_u32 v13, v13, v57, v58
    v_max_u32 v13, v13, v59
    v_cmp_eq_u32 vcc, 0xffbfffbf, v13
    s_cbranch_vccnz L_h_l
    s_branch L_h_g
L_h_x:
    s_mov_b32 s27, 0
    s_branch L_h_g
L_q_r0:
    buffer_load_dwordx4 v[24:27], v1, s[16:19], s69 offen offset:0 sc1
    buffer_load_dwordx4 v[28:31], v1, s[16:19], s69 offen offset:1024 sc1
    s_bitset1_b32 s90, 0
    s_branch L_q_n0
L_q_r1:
    buffer_load_dwordx4 v[32:35], v1, s[16:19], s69 offen offset:2048 sc1
    buffer_load_dwordx4 v[36:39], v1, s[16:19], s69 offen offset:3072 sc1
    s_bitset1_b32 s90, 1
    s_branch L_q_n1
L_q_r2:
    buffer_load_dwordx4 v[40:43], v1, s[16:19], s70 offen offset:0 sc1
    buffer_load_dwordx4 v[44:47], v1, s[16:19], s70 offen offset:1024 sc1
    s_bitset1_b32 s90, 2
    s_branch L_q_n2
L_q_enter:
    s_bitset1_b32 s90, 3
L_q_slow:
    s_cmp_eq_u32 s27, 0
    s_cbranch_scc1 L_q_out
    s_sub_u32 s27, s27, 1
    s_waitcnt vmcnt(0)
    s_bitcmp1_b32 s90, 0
    s_cbranch_scc0 L_q_s0
    v_max3_u32 v13, v24, v25, v26
    v_max3_u32 v13, v13, v27, v28
    v_max3_u32 v13, v13, v29, v30
    v_max_u32 v13, v13, v31
    v_cmp_eq_u32 vcc, 0xffbfffbf, v13
    s_cbranch_vccz L_q_v0
    buffer_load_dwordx4 v[24:27], v1, s[16:19], s69 offen offset:0 sc1
    buffer_load_dwordx4 v[28:31], v1, s[16:19], s69 offen offset:1024 sc1
    s_branch L_q_s0
L_q_v0:
    s_bitset0_b32 s90, 0
    v_mfma_f32_16x16x32_bf16 v[60:63], v[24:27], v[20:23], v[60:63]
    v_mfma_f32_16x16x32_bf16 v[56:59], v[24:27], v[80:83], v[56:59]
    v_mfma_f32_16x16x32_bf16 v[64:67], v[24:27], v[24:27], v[64:67]
    v_mfma_f32_16x16x32_bf16 v[60:63], v[28:31], v[20:23], v[60:63]
    v_mfma_f32_16x16x32_bf16 v[56:59], v[28:31], v[84:87], v[56:59]
    v_mfma_f32_16x16x32_bf16 v[64:67], v[28:31], v[28:31], v[64:67]
L_q_s0:
    s_bitcmp1_b32 s90, 1
    s_cbranch_scc0 L_q_s1
    v_max3_u32 v13, v32, v33, v34
    v_max3_u32 v13, v13, v35, v36
    v_max3_u32 v13, v13, v37, v38
    v_max_u32 v13, v13, v39
    v_cmp_eq_u32 vcc, 0xffbfffbf, v13
    s_cbranch_vccz L_q_v1
    buffer_load_dwordx4 v[32:35], v1, s[16:19], s69 offen offset:2048 sc1
    buffer_load_dwordx4 v[36:39], v1, s[16:19], s69 offen offset:3072 sc1
    s_branch L_q_s1
L_q_v1:
    s_bitset0_b32 s90, 1
    v_mfma_f32_16x16x32_bf16 v[60:63], v[32:35], v[20:23], v[60:63]
    v_mfma_f32_16x16x32_bf16 v[56:59], v[32:35], v[88:91], v[56:59]
    v_mfma_f32_16x16x32_bf16 v[64:67], v[32:35], v[32:35], v[64:67]
    v_mfma_f32_16x16x32_bf16 v[60:63], v[36:39], v[20:23], v[60:63]
    v_mfma_f32_16x16x32_bf16 v[56:59], v[36:39], v[92:95], v[56:59]
    v_mfma_f32_16x16x32_bf16 v[64:67], v[36:39], v[36:39], v[64:67]
L_q_s1:
    s_bitcmp1_b32 s90, 2
    s_cbranch_scc0 L_q_s2
    v_max3_u32 v13, v40, v41, v42
    v_max3_u32 v13, v13, v43, v44
    v_max3_u32 v13, v13, v45, v46
    v_max_u32 v13, v13, v47
    v_cmp_eq_u32 vcc, 0xffbfffbf, v13
    s_cbranch_vccz L_q_v2
    buffer_load_dwordx4 v[40:43], v1, s[16:19], s70 offen offset:0 sc1
    buffer_load_dwordx4 v[44:47], v1, s[16:19], s70 offen offset:1024 sc1
    s_branch L_q_s2
L_q_v2:
    s_bitset0_b32 s90, 2
    v_mfma_f32_16x16x32_bf16 v[60:63], v[40:43], v[20:23], v[60:63]
    v_mfma_f32_16x16x32_bf16 v[56:59], v[40:43], v[80:83], v[56:59]
    v_mfma_f32_16x16x32_bf16 v[60:63], v[44:47], v[20:23], v[60:63]
    v_mfma_f32_16x16x32_bf16 v[56:59], v[44:47], v[84:87], v[56:59]
L_q_s2:
    s_bitcmp1_b32 s90, 3
    s_cbranch_scc0 L_q_s3
    v_max3_u32 v13, v48, v49, v50
    v_max3_u32 v13, v13, v51, v52
    v_max3_u32 v13, v13, v53, v54
    v_max_u32 v13, v13, v55
    v_cmp_eq_u32 vcc, 0xffbfffbf, v13
    s_cbranch_vccz L_q_v3
    buffer_load_dwordx4 v[48:51], v1, s[16:19], s70 offen offset:2048 sc1
    buffer_load_dwordx4 v[52:55], v1, s[16:19], s70 offen offset:3072 sc1
    s_branch L_q_s3
L_q_v3:
    s_bitset0_b32 s90, 3
    v_mfma_f32_16x16x32_bf16 v[60:63], v[48:51], v[20:23], v[60:63]
    v_mfma_f32_16x16x32_bf16 v[56:59], v[48:51], v[88:91], v[56:59]
    v_mfma_f32_16x16x32_bf16 v[60:63], v[52:55], v[20:23], v[60:63]
    v_mfma_f32_16x16x32_bf16 v[56:59], v[52:55], v[92:95], v[56:59]
L_q_s3:
    s_cmp_lg_u32 s90, 0
    s_cbranch_scc1 L_q_slow
L_q_out:
    s_nop 7
    v_mov_b32 v76, v56
    v_mov_b32 v68, v60
    v_mov_b32 v77, v57
    v_mov_b32 v69, v61
    v_mov_b32 v78, v58
    v_mov_b32 v70, v62
    v_mov_b32 v79, v59
    v_mov_b32 v71, v63
    s_nop 1
    s_branch L_q_done
L_slow112:
    s_waitcnt lgkmcnt(1)
    v_pk_add_f32 v[56:57], v[56:57], v[58:59]
    s_waitcnt lgkmcnt(0)
    v_pk_add_f32 v[76:77], v[76:77], v[78:79]
    v_pk_add_f32 v[56:57], v[56:57], v[76:77]
    s_mov_b32 exec_hi, 0
    v_cvt_pk_bf16_f32 v58, v56, v57
    buffer_store_dword v58, v74, s[16:19], s32 offen sc1
    s_mov_b64 exec, -1
    s_branch L_slow112b
L_q2_2:
    buffer_load_dwordx4 v[76:79], v1, s[16:19], s33 offen sc1
L_pad13:
    s_cbranch_execz L_ret
    s_waitcnt vmcnt(1)
    v_max3_u32 v13, v76, v77, v78
    v_max_u32 v13, v13, v79
    v_cmp_eq_u32 vcc, 0xffbfffbf, v13
    s_cbranch_vccz L_q2_g
L_q2_l:
    buffer_load_dwordx4 v[76:79], v1, s[16:19], s33 offen sc1
    s_sub_u32 s27, s27, 1
    s_cbranch_scc1 L_q2_x
    s_waitcnt vmcnt(1)
    v_max3_u32 v13, v76, v77, v78
    v_max_u32 v13, v13, v79
    v_cmp_eq_u32 vcc, 0xffbfffbf, v13
    s_cbranch_vccnz L_q2_l
    s_branch L_q2_g
L_q2_x:
    s_mov_b32 s27, 0
    s_branch L_q2_g
L_z_l:
    buffer_load_dwordx4 v[52:55], v1, s[16:19], s76 offen sc1
    buffer_load_dwordx4 v[56:59], v1, s[16:19], s76 offen offset:1024 sc1
    s_sub_u32 s27, s27, 1
    s_cbranch_scc1 L_z_x
    s_waitcnt vmcnt(0)
    v_max3_u32 v13, v52, v53, v54
    v_max3_u32 v13, v13, v55, v56
    v_max3_u32 v13, v13, v57, v58
    v_max_u32 v13, v13, v59
    v_cmp_eq_u32 vcc, 0xffbfffbf, v13
    s_cbranch_vccnz L_z_l
    s_branch L_z_s
L_z_x:
    s_mov_b32 s27, 0
    s_branch L_z_g
L_codeend:
    s_endpgm
.section .rodata,"a"
.p2align 6
.amdhsa_kernel interleave_layers__gqa_block_cached__glu_gated_bilinear__decode_kernel
  .amdhsa_next_free_vgpr 512
  .amdhsa_next_free_sgpr 102
  .amdhsa_accum_offset 256
  .amdhsa_group_segment_fixed_size 0
  .amdhsa_kernarg_size 96
  .amdhsa_user_sgpr_count 2
  .amdhsa_user_sgpr_kernarg_segment_ptr 1
  .amdhsa_system_sgpr_workgroup_id_x 1
  .amdhsa_float_denorm_mode_32 3
.end_amdhsa_kernel
```
